```python
import torch

def _softmax(x, axis=-1):
    return torch.softmax(x, dim=axis)
def _gelu(x):
    return torch.nn.functional.gelu(x, approximate="tanh")
def _silu(x):
    return torch.nn.functional.silu(x)
def _sigmoid(x):
    return torch.sigmoid(x)
def _layernorm(x, axis=-1, eps=1e-5):
    m = x.mean(dim=axis, keepdim=True)
    v = x.var(dim=axis, keepdim=True, unbiased=False)
    return (x - m) / torch.sqrt(v + eps)
def _scatter_add(tgt, idx, src, axis=0):
    return tgt.clone().index_add_(axis, idx, src)
def _segment_sum(src, seg, n):
    out = torch.zeros((n,) + src.shape[1:], dtype=src.dtype)
    return out.index_add_(0, seg, src)
def _pad(x, pw):
    flat = tuple(v for pair in reversed(pw) for v in pair)
    return torch.nn.functional.pad(x, flat)

kernel_name = 'standalone__edge_featured_mpnn_mpnn__graph'

def setup_inputs():

    _w = (lambda a: (lambda t: t.to(torch.bfloat16) if t.is_floating_point() else t)(torch.as_tensor(a)))
    N, deg, D, De = 25000, 32, 64, max(16, 1)
    E = N * deg
    H = 2 * D
    return {
        "x": _w((lambda *s: torch.randn(*s, dtype=torch.bfloat16) * 0.05)(N, D)),
        "e_attr": _w((lambda *s: torch.randn(*s, dtype=torch.bfloat16) * 0.8)(E, De)),
        "src": _w((lambda lo, hi, *s: torch.randint(lo, hi, s))(0, N, E).to(torch.int64)),
        "dst": _w((lambda lo, hi, *s: torch.randint(lo, hi, s))(0, N, E).to(torch.int64)),
        "w1": _w((lambda *s: torch.randn(*s, dtype=torch.bfloat16) * 0.8)(2 * D + De, H) * (1.0 / (2 * D + De) ** 0.5)),
        "b1": _w((lambda *s: torch.randn(*s, dtype=torch.bfloat16) * 0.8)(H) * 0.01),
        "w2": _w((lambda *s: torch.randn(*s, dtype=torch.bfloat16) * 0.05)(H, D) * (1.0 / H ** 0.5)),
        "b2": _w((lambda *s: torch.randn(*s, dtype=torch.bfloat16) * 0.05)(D) * 0.01),
    }

def reference(x, e_attr, src, dst, w1, b1, w2, b2):
    N, D = x.shape
    h_src = x[src]
    h_dst = x[dst]
    m_in = torch.concatenate([h_src, h_dst, e_attr], axis=-1)
    h = _silu(m_in @ w1 + b1)
    msg = h @ w2 + b2
    return _segment_sum(msg, dst, N)
```

```asm
; @launch grid=(256,1,1) block=(512,1,1) lds=160960
.amdgcn_target "amdgcn-amd-amdhsa--gfx950"
.text
.globl standalone__edge_featured_mpnn_mpnn__graph_kernel
.p2align 12
.p2align 8
.type standalone__edge_featured_mpnn_mpnn__graph_kernel,@function
standalone__edge_featured_mpnn_mpnn__graph_kernel:
    s_cmp_ge_u32 s2, 256
    s_cbranch_scc1 M_END
    s_load_dwordx16 s[40:55], s[0:1], 0
    s_load_dwordx4 s[12:15], s[0:1], 64
    s_load_dwordx2 s[20:21], s[0:1], 80
    v_lshrrev_b32 v2, 6, v0
    v_and_b32 v28, 63, v0
    v_mov_b32 v160, v0
    v_readfirstlane_b32 s36, v2
    v_lshlrev_b32 v161, 4, v0
    s_cmp_lg_u32 s36, 7
    s_cbranch_scc1 A_RY
    s_lshr_b32 s35, s2, 3
    s_mov_b32 s34, 0
A_HOP:
    s_mov_b64 exec, 0
    s_bitcmp1_b32 s35, 3
    s_cbranch_scc1 A_H1
    s_bitcmp1_b32 s35, 2
    s_cbranch_scc1 A_H01
    s_bitcmp1_b32 s35, 1
    s_cbranch_scc1 A_H001
    s_bitcmp1_b32 s35, 0
    s_cbranch_scc1 M_H1
    s_branch M_H0
A_H001:
    s_bitcmp1_b32 s35, 0
    s_cbranch_scc1 M_H3
    s_branch M_H2
A_H01:
    s_bitcmp1_b32 s35, 1
    s_cbranch_scc1 A_H011
    s_bitcmp1_b32 s35, 0
    s_cbranch_scc1 M_H5
    s_branch M_H4
A_H011:
    s_bitcmp1_b32 s35, 0
    s_cbranch_scc1 M_H7
    s_branch M_H6
A_H1:
    s_bitcmp1_b32 s35, 2
    s_cbranch_scc1 A_H11
    s_bitcmp1_b32 s35, 1
    s_cbranch_scc1 A_H101
    s_bitcmp1_b32 s35, 0
    s_cbranch_scc1 M_H9
    s_branch M_H8
A_H101:
    s_bitcmp1_b32 s35, 0
    s_cbranch_scc1 M_H11
    s_branch M_H10
A_H11:
    s_bitcmp1_b32 s35, 1
    s_cbranch_scc1 A_H111
    s_bitcmp1_b32 s35, 0
    s_cbranch_scc1 M_H13
    s_branch M_H12
A_H111:
    s_bitcmp1_b32 s35, 0
    s_cbranch_scc1 M_H15
    s_branch M_H14
A_RET:
    s_mov_b64 exec, -1
    s_cmp_lg_u32 s34, 0
    s_cbranch_scc1 A_RT2
A_RY:
    s_and_b32 s3, s2, 7
    s_lshl_b32 s3, s3, 5
    s_lshr_b32 s62, s2, 3
    s_add_u32 s3, s3, s62
    s_xor_b32 s62, s3, 31
    s_mul_i32 s63, s62, 12800
    v_lshlrev_b32 v24, 4, v28
    s_add_u32 s38, s63, 6400
    v_mov_b32 v228, 0
    v_lshlrev_b32 v229, 2, v0
    v_and_b32 v230, 60, v229
    v_add_u32 v230, 159872, v230
    ds_write_b32 v229, v228 offset:63488
    ds_write_b32 v230, v228
    s_cmp_lt_u32 s62, 250
    s_cselect_b32 s37, 400, 0
    v_cmp_gt_u32 s[58:59], s37, v0
    s_mov_b32 s6, 0x30d400
    s_mov_b32 s7, 0x20000
    s_mov_b32 s10, 0x30d400
    s_mov_b32 s11, 0x20000
    s_mov_b32 s22, 0x1200000
    s_mov_b32 s23, 0x20000
    s_mov_b32 s26, 0x9000
    s_mov_b32 s27, 0x20000
    s_mov_b32 s30, 0x4000
    s_mov_b32 s31, 0x20000
    s_waitcnt lgkmcnt(0)
    s_mov_b64 s[4:5], s[46:47]
    s_mov_b64 s[8:9], s[44:45]
    s_mov_b64 exec, s[58:59]
    s_cbranch_execz A_L1
    buffer_load_dwordx4 v[164:167], v161, s[4:7], s63 offen nt
    buffer_load_dwordx4 v[168:171], v161, s[4:7], s38 offen nt
A_L1:
    s_mov_b64 exec, -1
    s_mov_b64 s[24:25], s[48:49]
    s_mov_b64 s[28:29], s[52:53]
    s_cmp_lt_u32 s36, 6
    s_cbranch_scc1 A_L2
    s_mov_b64 s[4:5], s[14:15]
    s_movk_i32 s6, 256
    s_cmp_eq_u32 s36, 7
    s_cbranch_scc1 A_L2B
    s_cmp_lg_u32 s62, 255
    s_cbranch_scc1 A_L2
    v_mul_u32_u24 v84, 256, v28
    v_mov_b32 v88, 0
    v_mov_b32 v89, 0
    v_mov_b32 v90, 0
    v_mov_b32 v91, 0
    s_mov_b32 s60, 0xc00000
    buffer_store_dwordx4 v[88:91], v84, s[20:23], s60 offen offset:0 sc1
    buffer_load_dword v79, off, s[4:7], 0 sc1
    s_branch A_L2
A_L2B:
    s_lshr_b32 s60, s2, 3
    v_lshlrev_b32 v82, 12, v28
    s_lshl_b32 s60, s60, 7
    s_mov_b64 s[8:9], s[50:51]
    s_movk_i32 s10, 256
    v_lshlrev_b32 v84, 2, v28
    s_mov_b64 exec, 1
    buffer_load_dword v79, off, s[4:7], 0 sc1
    s_mov_b64 exec, -1
    buffer_load_dword v80, v84, s[8:11], 0 offen
    s_mov_b64 s[8:9], s[54:55]
    s_movk_i32 s10, 128
    buffer_load_dword v81, v84, s[8:11], 0 offen
    buffer_load_dword v83, v82, s[28:31], s60 offen
    buffer_load_dword v83, v82, s[24:27], s60 offen
A_L2:
    s_mov_b64 s[32:33], s[12:13]
    s_mov_b64 s[12:13], s[40:41]
    s_mov_b64 s[16:17], s[42:43]
    s_mov_b32 s40, 0
    s_lshl_b32 s54, s3, 6
    s_lshl_b32 s3, s3, 3
    s_mov_b32 s46, 0xc3569ae6
    s_add_u32 s44, s3, s36
    s_lshl_b32 s45, s44, 13
    s_add_u32 s45, s45, 670
    s_mul_hi_u32 s45, s45, s46
    s_lshr_b32 s45, s45, 9
    v_and_b32 v25, 48, v28
    v_subrev_u32 v31, s45, v28
    v_and_b32 v31, 15, v31
    v_add_u32 v31, s45, v31
    v_lshl_add_u32 v78, v31, 7, v25
    v_lshlrev_b32 v76, 1, v25
    v_xor_b32 v76, v76, v24
    v_xor_b32 v77, 128, v76
    s_mov_b32 s14, 0x30d400
    s_mov_b32 s15, 0x20000
    s_mov_b32 s18, 0x186a000
    s_mov_b32 s19, 0x20000
    s_mov_b64 exec, s[58:59]
    s_cbranch_execz A_L7
    buffer_load_dwordx4 v[172:175], v161, s[8:11], s63 offen nt
    buffer_load_dwordx4 v[176:179], v161, s[8:11], s38 offen nt
A_L7:
    s_mov_b64 exec, -1
    s_mov_b32 s34, 2
    s_movk_i32 s56, 128
    s_mov_b32 s57, 0
    s_mul_i32 s47, s36, 5120
    s_add_u32 s43, s47, 73728
    s_add_u32 s47, s47, 8192
    s_mul_i32 s48, s36, 272
    s_add_u32 s48, s48, 157696
    v_lshrrev_b32 v26, 4, v28
    v_lshlrev_b32 v17, 3, v28
    s_mov_b32 s51, 0x11111111
    s_mov_b32 s42, 0x44444444
    v_lshl_add_u32 v20, v28, 5, s47
    v_lshl_add_u32 v21, v28, 4, s47
    v_lshrrev_b32 v19, 3, v28
    v_lshl_add_u32 v6, v19, 4, s47
    v_and_b32 v31, 3, v28
    v_bfe_u32 v30, v28, 3, 1
    v_lshl_or_b32 v31, v30, 2, v31
    v_bfe_u32 v30, v28, 4, 1
    v_lshl_or_b32 v31, v31, 1, v30
    v_bfe_u32 v30, v28, 2, 1
    v_lshl_or_b32 v31, v31, 1, v30
    s_add_u32 s50, s47, 2048
    s_add_u32 s45, s47, 4096
    v_lshl_add_u32 v7, v31, 2, s50
    v_and_b32 v31, 29, v31
    v_lshl_add_u32 v9, v31, 1, s45
    v_bfe_u32 v31, v28, 2, 3
    v_lshrrev_b32 v30, 5, v28
    v_lshl_add_u32 v31, v31, 1, v30
    v_lshl_add_u32 v8, v31, 2, s45
    s_mov_b32 exec_hi, 0
    v_mov_b32 v9, 157248
    s_mov_b32 exec_hi, -1
M_H0:
    s_cbranch_execz A_RET
    v_lshlrev_b32 v3, 4, v30
    v_lshlrev_b32 v29, 7, v30
    v_and_b32 v29, v29, v17
    v_add_u32 v31, s48, v17
    v_mov_b32 v34, 0
    v_mov_b32 v35, 0
    s_mov_b32 exec_hi, 3
    ds_write_b64 v31, v[34:35]
    s_mov_b64 exec, -1
    v_and_b32 v18, 7, v28
    v_xor_b32 v27, v18, v26
    v_lshlrev_b32 v2, 4, v27
    s_mov_b32 s44, 159872
    v_lshl_add_u32 v18, v18, 1, s44
    v_lshl_add_u32 v19, v19, 1, s44
    v_and_b32 v16, 3, v28
    v_bfe_u32 v30, v28, 2, 1
    v_lshl_or_b32 v16, v30, 3, v16
    v_bfe_u32 v30, v28, 3, 1
    v_lshl_or_b32 v16, v30, 2, v16
    v_lshrrev_b32 v27, 1, v16
    v_xor_b32 v27, v27, v26
    v_lshl_add_u32 v31, v16, 7, s43
    v_lshl_add_u32 v0, v27, 4, v31
    v_xor_b32 v1, 64, v0
    v_and_b32 v27, 15, v28
    s_mov_b32 s44, 155648
    v_lshl_add_u32 v23, v27, 5, s44
    s_add_u32 s44, s43, 4096
    v_lshl_add_u32 v27, v27, 4, s44
    v_lshl_add_u32 v27, v26, 9, v27
    v_mov_b32 v31, 156672
    v_cmp_gt_u32 vcc, 32, v28
    v_and_b32 v30, 3, v28
    v_mul_u32_u24 v4, 72, v30
    s_movk_i32 s44, 0x88
    v_and_or_b32 v4, v4, s44, v31
    v_cndmask_b32 v5, v31, v27, vcc
    v_mov_b32 v10, 0xdddd0000
    s_mov_b32 s44, 114688
    v_lshl_add_u32 v65, v30, 3, s44
    v_bfe_u32 v31, v28, 2, 3
    v_lshl_or_b32 v65, v31, 5, v65
    v_and_b32 v31, 3, v31
    v_lshl_or_b32 v65, v31, 8, v65
    v_lshl_or_b32 v65, v26, 11, v65
    s_lshl_b32 s44, s36, 5
    v_xor_b32 v64, s44, v65
    v_and_b32 v14, 0xffffefff, v64
    v_lshl_or_b32 v14, v3, 6, v14
    v_xor_b32 v66, 32, v65
    v_xor_b32 v67, 64, v65
    v_xor_b32 v68, 96, v65
    v_xor_b32 v69, 128, v65
    v_xor_b32 v70, 160, v65
    v_xor_b32 v71, 192, v65
    v_xor_b32 v72, 224, v65
    v_and_b32 v228, 60, v28
    v_lshl_add_u32 v228, s36, 7, v228
    v_mul_u32_u24 v229, 40, v228
    v_lshl_add_u32 v229, v30, 4, v229
    v_lshl_add_u32 v230, s36, 11, v24
    s_lshl_b32 s39, s62, 14
    s_add_u32 s55, s39, 0x400000
    s_barrier
    s_lshl_b32 s38, s36, 12
    s_add_u32 m0, s38, 122880
    s_nop 0
    buffer_load_dwordx4 v76, s[24:27], s38 offen offset:0 lds
    buffer_load_dwordx4 v76, s[24:27], s38 offen offset:1024 lds
    s_lshl_b32 s44, s62, 3
    s_add_u32 s44, s44, s36
    s_cmp_lg_u32 s44, 2046
    s_cbranch_scc1 A_NF
    v_mov_b32 v89, 1
    s_waitcnt vmcnt(2)
    s_mov_b64 exec, 1
    buffer_store_dword v89, off, s[4:7], 0 sc1
    s_mov_b64 exec, -1
A_NF:
    s_lshl_b32 s45, s36, 25
    s_or_b32 s45, s45, 0x8000
    v_lshl_or_b32 v31, v28, 19, s45
    s_mov_b32 s45, 0xf4b8aa3b
    s_mov_b32 s44, 0xbfb8c150
    v_mul_f32 v32, s45, v31
    v_exp_f32 v48, v32
    v_add_u32 v33, 0x10000, v31
    v_mul_f32 v33, s45, v33
    v_exp_f32 v49, v33
    v_add_u32 v34, 0x20000, v31
    v_mul_f32 v34, s45, v34
    v_exp_f32 v50, v34
    v_add_u32 v35, 0x30000, v31
    v_mul_f32 v35, s45, v35
    v_exp_f32 v51, v35
    v_add_u32 v36, 0x40000, v31
    v_mul_f32 v36, s45, v36
    v_exp_f32 v52, v36
    v_add_u32 v37, 0x50000, v31
    v_mul_f32 v37, s45, v37
    v_exp_f32 v53, v37
    v_add_u32 v38, 0x60000, v31
    v_mul_f32 v38, s45, v38
    v_exp_f32 v54, v38
    v_add_u32 v39, 0x70000, v31
    v_mul_f32 v39, s45, v39
    v_exp_f32 v55, v39
    s_mov_b32 s45, 0xbfb89326
    v_fma_f32 v40, v48, s44, s44
    v_rcp_f32 v40, v40
    v_fma_f32 v41, v49, s45, s45
    v_rcp_f32 v41, v41
    v_fma_f32 v42, v50, s44, s44
    v_rcp_f32 v42, v42
    v_fma_f32 v43, v51, s45, s45
    v_rcp_f32 v43, v43
    v_fma_f32 v44, v52, s44, s44
    v_rcp_f32 v44, v44
    v_fma_f32 v45, v53, s45, s45
    v_rcp_f32 v45, v45
    v_fma_f32 v46, v54, s44, s44
    v_rcp_f32 v46, v46
    v_fma_f32 v47, v55, s45, s45
    v_rcp_f32 v47, v47
    s_lshl_b32 s45, s36, 10
    v_lshl_add_u32 v31, v28, 4, s45
    v_add_u32 v30, 65536, v31
    v_mul_f32 v40, v32, v40
    v_mul_f32 v48, -v40, v48
    v_mul_f32 v41, v33, v41
    v_mul_f32 v49, -v41, v49
    v_mul_f32 v42, v34, v42
    v_mul_f32 v50, -v42, v50
    v_mul_f32 v43, v35, v43
    v_mul_f32 v51, -v43, v51
    v_mul_f32 v44, v36, v44
    v_mul_f32 v52, -v44, v52
    v_mul_f32 v45, v37, v45
    v_mul_f32 v53, -v45, v53
    v_mul_f32 v46, v38, v46
    v_mul_f32 v54, -v46, v54
    v_mul_f32 v47, v39, v47
    v_mul_f32 v55, -v47, v55
    v_cvt_pk_bf16_f32 v32, v40, v41
    v_cvt_pk_bf16_f32 v33, v42, v43
    v_cvt_pk_bf16_f32 v34, v44, v45
    v_cvt_pk_bf16_f32 v35, v46, v47
    v_cvt_pk_bf16_f32 v36, v48, v49
    v_cvt_pk_bf16_f32 v37, v50, v51
    v_cvt_pk_bf16_f32 v38, v52, v53
    v_cvt_pk_bf16_f32 v39, v54, v55
    ds_write_b128 v31, v[32:35] offset:0
    ds_write_b128 v30, v[36:39]
    buffer_load_dwordx4 v[56:59], v78, s[12:15], 0 offen offset:0
    buffer_load_dwordx4 v[60:63], v78, s[12:15], 0 offen offset:64
    s_cmp_ge_u32 s62, 250
    s_cbranch_scc1 A_SPARE
    s_movk_i32 s45, 40
    s_mov_b64 exec, s[58:59]
    s_cbranch_execz A_W6
    v_lshlrev_b32 v234, 18, v160
    v_mov_b32 v235, 8196
    s_waitcnt vmcnt(7)
    v_mul_u32_u24 v188, 5368, v164
    v_mul_u32_u24 v180, 671, v164
    v_mul_u32_u24 v189, 5368, v165
M_H1:
    s_cbranch_execz A_RET
    v_mul_u32_u24 v181, 671, v165
    v_mul_u32_u24 v190, 5368, v166
    v_mul_u32_u24 v182, 671, v166
    v_mul_u32_u24 v191, 5368, v167
    v_mul_u32_u24 v183, 671, v167
    v_lshlrev_b32_sdwa v188, 2, v188 dst_sel:DWORD dst_unused:UNUSED_PAD src0_sel:DWORD src1_sel:WORD_1
    v_lshlrev_b32_sdwa v180, 2, v180 dst_sel:DWORD dst_unused:UNUSED_PAD src0_sel:DWORD src1_sel:BYTE_2
    v_lshlrev_b32 v196, v188, 1
    ds_add_rtn_u32 v204, v180, v196 offset:63488
    v_lshlrev_b32_sdwa v189, 2, v189 dst_sel:DWORD dst_unused:UNUSED_PAD src0_sel:DWORD src1_sel:WORD_1
    v_lshlrev_b32_sdwa v181, 2, v181 dst_sel:DWORD dst_unused:UNUSED_PAD src0_sel:DWORD src1_sel:BYTE_2
    v_lshlrev_b32 v197, v189, 1
    ds_add_rtn_u32 v205, v181, v197 offset:63488
    v_lshlrev_b32_sdwa v190, 2, v190 dst_sel:DWORD dst_unused:UNUSED_PAD src0_sel:DWORD src1_sel:WORD_1
    v_lshlrev_b32_sdwa v182, 2, v182 dst_sel:DWORD dst_unused:UNUSED_PAD src0_sel:DWORD src1_sel:BYTE_2
    v_lshlrev_b32 v198, v190, 1
    ds_add_rtn_u32 v206, v182, v198 offset:63488
    v_lshlrev_b32_sdwa v191, 2, v191 dst_sel:DWORD dst_unused:UNUSED_PAD src0_sel:DWORD src1_sel:WORD_1
    v_lshlrev_b32_sdwa v183, 2, v183 dst_sel:DWORD dst_unused:UNUSED_PAD src0_sel:DWORD src1_sel:BYTE_2
    v_lshlrev_b32 v199, v191, 1
    ds_add_rtn_u32 v207, v183, v199 offset:63488
    s_waitcnt vmcnt(6)
    v_mul_u32_u24 v192, 5368, v168
    v_mul_u32_u24 v184, 671, v168
    v_mul_u32_u24 v193, 5368, v169
    v_mul_u32_u24 v185, 671, v169
    v_mul_u32_u24 v194, 5368, v170
    v_mul_u32_u24 v186, 671, v170
    v_mul_u32_u24 v195, 5368, v171
    v_mul_u32_u24 v187, 671, v171
    v_lshlrev_b32_sdwa v192, 2, v192 dst_sel:DWORD dst_unused:UNUSED_PAD src0_sel:DWORD src1_sel:WORD_1
    v_lshlrev_b32_sdwa v184, 2, v184 dst_sel:DWORD dst_unused:UNUSED_PAD src0_sel:DWORD src1_sel:BYTE_2
    v_lshlrev_b32 v200, v192, 1
    ds_add_rtn_u32 v208, v184, v200 offset:63488
    v_lshlrev_b32_sdwa v193, 2, v193 dst_sel:DWORD dst_unused:UNUSED_PAD src0_sel:DWORD src1_sel:WORD_1
    v_lshlrev_b32_sdwa v185, 2, v185 dst_sel:DWORD dst_unused:UNUSED_PAD src0_sel:DWORD src1_sel:BYTE_2
    v_lshlrev_b32 v201, v193, 1
    ds_add_rtn_u32 v209, v185, v201 offset:63488
    v_lshlrev_b32_sdwa v194, 2, v194 dst_sel:DWORD dst_unused:UNUSED_PAD src0_sel:DWORD src1_sel:WORD_1
    v_lshlrev_b32_sdwa v186, 2, v186 dst_sel:DWORD dst_unused:UNUSED_PAD src0_sel:DWORD src1_sel:BYTE_2
    v_lshlrev_b32 v202, v194, 1
    ds_add_rtn_u32 v210, v186, v202 offset:63488
    v_lshlrev_b32_sdwa v195, 2, v195 dst_sel:DWORD dst_unused:UNUSED_PAD src0_sel:DWORD src1_sel:WORD_1
    v_lshlrev_b32_sdwa v187, 2, v187 dst_sel:DWORD dst_unused:UNUSED_PAD src0_sel:DWORD src1_sel:BYTE_2
    v_lshlrev_b32 v203, v195, 1
    ds_add_rtn_u32 v211, v187, v203 offset:63488
    v_lshl_or_b32 v220, v164, 28, v234
    v_mad_u32_u24 v212, v180, s45, v235
    v_add_u32 v234, 0x10000, v234
    v_bfe_u32 v196, s42, 0, v188
    v_lshl_or_b32 v221, v165, 28, v234
    v_mad_u32_u24 v213, v181, s45, v235
    v_add_u32 v234, 0x10000, v234
    v_bfe_u32 v197, s42, 0, v189
    v_lshl_or_b32 v222, v166, 28, v234
    v_mad_u32_u24 v214, v182, s45, v235
    v_add_u32 v234, 0x10000, v234
    v_bfe_u32 v198, s42, 0, v190
    v_lshl_or_b32 v223, v167, 28, v234
    v_mad_u32_u24 v215, v183, s45, v235
    v_add_u32 v234, 0x63d0000, v234
    v_bfe_u32 v199, s42, 0, v191
    v_lshl_or_b32 v224, v168, 28, v234
    v_mad_u32_u24 v216, v184, s45, v235
    v_add_u32 v234, 0x10000, v234
    v_bfe_u32 v200, s42, 0, v192
    v_lshl_or_b32 v225, v169, 28, v234
    v_mad_u32_u24 v217, v185, s45, v235
    v_add_u32 v234, 0x10000, v234
    v_bfe_u32 v201, s42, 0, v193
    v_lshl_or_b32 v226, v170, 28, v234
    v_mad_u32_u24 v218, v186, s45, v235
    v_add_u32 v234, 0x10000, v234
    v_bfe_u32 v202, s42, 0, v194
    v_lshl_or_b32 v227, v171, 28, v234
    v_mad_u32_u24 v219, v187, s45, v235
    v_bfe_u32 v203, s42, 0, v195
A_S2:
    s_mov_b64 exec, -1
A_S2R:
    s_waitcnt lgkmcnt(0)
    s_barrier
    ds_read_b32 v236, v228 offset:63488
    ds_read_b32 v237, v228 offset:63552
    s_mov_b64 exec, s[58:59]
    ds_read_b32 v180, v180 offset:63488
    ds_read_b32 v181, v181 offset:63488
    ds_read_b32 v182, v182 offset:63488
    ds_read_b32 v183, v183 offset:63488
    ds_read_b32 v184, v184 offset:63488
    ds_read_b32 v185, v185 offset:63488
    ds_read_b32 v186, v186 offset:63488
    ds_read_b32 v187, v187 offset:63488
    s_mov_b64 exec, -1
    s_lshl_b32 s38, s36, 12
    s_add_u32 m0, s38, 122880
    s_nop 0
    buffer_load_dwordx4 v77, s[24:27], s38 offen offset:2048 lds
    buffer_load_dwordx4 v77, s[24:27], s38 offen offset:3072 lds
    s_cmp_eq_u32 s36, 7
    s_cbranch_scc1 A_W7
    s_mov_b64 exec, s[58:59]
    s_cbranch_execz A_S4
    v_bfe_u32 v204, v204, v188, 4
    v_bfe_u32 v205, v205, v189, 4
    v_bfe_u32 v206, v206, v190, 4
    v_bfe_u32 v207, v207, v191, 4
    v_bfe_u32 v208, v208, v192, 4
    v_bfe_u32 v209, v209, v193, 4
    v_bfe_u32 v210, v210, v194, 4
    v_bfe_u32 v211, v211, v195, 4
    v_max3_u32 v234, v204, v205, v206
    v_max3_u32 v234, v234, v207, v208
    v_max3_u32 v234, v234, v209, v210
    v_max_u32 v234, v234, v211
    v_lshl_add_u32 v204, v204, 2, v212
    v_lshl_add_u32 v205, v205, 2, v213
    v_lshl_add_u32 v206, v206, 2, v214
    v_lshl_add_u32 v207, v207, 2, v215
    v_lshl_add_u32 v208, v208, 2, v216
    v_lshl_add_u32 v209, v209, 2, v217
    v_lshl_add_u32 v210, v210, 2, v218
    v_lshl_add_u32 v211, v211, 2, v219
    v_cmp_eq_u32 s[60:61], 15, v234
    s_waitcnt vmcnt(6)
    v_lshl_or_b32 v172, v172, 1, v220
    v_lshl_or_b32 v173, v173, 1, v221
    v_lshl_or_b32 v174, v174, 1, v222
    v_lshl_or_b32 v175, v175, 1, v223
    v_lshl_or_b32 v176, v176, 1, v224
    v_lshl_or_b32 v177, v177, 1, v225
    v_lshl_or_b32 v178, v178, 1, v226
    v_lshl_or_b32 v179, v179, 1, v227
    s_waitcnt lgkmcnt(0)
    v_dot8_u32_u4 v180, v180, v196, v204
    v_dot8_u32_u4 v181, v181, v197, v205
    v_dot8_u32_u4 v182, v182, v198, v206
M_H2:
    s_cbranch_execz A_RET
    v_dot8_u32_u4 v183, v183, v199, v207
    v_dot8_u32_u4 v184, v184, v200, v208
    v_dot8_u32_u4 v185, v185, v201, v209
    v_dot8_u32_u4 v186, v186, v202, v210
    v_dot8_u32_u4 v187, v187, v203, v211
    ds_write_b32 v180, v172
    ds_write_b32 v181, v173
    ds_write_b32 v182, v174
    ds_write_b32 v183, v175
    ds_write_b32 v184, v176
    ds_write_b32 v185, v177
    ds_write_b32 v186, v178
    ds_write_b32 v187, v179
A_S4:
    s_mov_b64 exec, -1
    v_dot8_u32_u4 v232, v236, s42, 0
    v_dot8_u32_u4 v233, v237, s42, 0
    v_mov_b32 v34, 64516
    v_mov_b32 v231, 0x7ffffff0
    s_mov_b32 s41, 0
    v_max_u32 v35, v232, v233
    s_movk_i32 s44, 124
    v_cmp_lt_u32 vcc, 140, v35
    v_cmp_lt_u32 s[52:53], s44, v35
    s_or_b64 vcc, vcc, s[60:61]
    s_cbranch_scc0 A_S4B
    ds_write_b32 v34, v34
A_S4B:
    s_mov_b32 s60, s51
    s_mov_b32 s61, s51
    s_waitcnt lgkmcnt(0)
    s_barrier
    ds_read_b32 v35, v34
    ds_read_b128 v[240:243], v229 offset:8192
    ds_read_b128 v[244:247], v229 offset:10752
    ds_read_b128 v[248:251], v229 offset:8256
    ds_read_b128 v[252:255], v229 offset:10816
    s_waitcnt lgkmcnt(4)
    v_readfirstlane_b32 s44, v35
    s_nop 0
    s_cmp_lg_u32 s44, 0
    s_cbranch_scc1 A_SLOW
A_OUT:
    v_cmp_lt_u32 vcc, 60, v232
    v_cmp_lt_u32 s[44:45], 60, v233
    s_nop 0
    v_cndmask_b32 v232, v231, v230, vcc
    v_cndmask_b32 v233, v231, v230, s[44:45]
    s_waitcnt lgkmcnt(3)
    v_cndmask_b32 v240, v240, v236, s[60:61]
    buffer_store_dwordx4 v[240:243], v230, s[20:23], s39 offen offset:0 sc1
    s_waitcnt lgkmcnt(2)
    v_cndmask_b32 v244, v244, v237, s[60:61]
    buffer_store_dwordx4 v[244:247], v230, s[20:23], s39 offen offset:1024 sc1
    s_waitcnt lgkmcnt(1)
    buffer_store_dwordx4 v[248:251], v232, s[20:23], s55 offen offset:0 sc1
    s_waitcnt lgkmcnt(0)
    buffer_store_dwordx4 v[252:255], v233, s[20:23], s55 offen offset:1024 sc1
    s_mov_b64 exec, s[52:53]
    s_cbranch_execz A_S5
    s_cmp_lg_u32 s41, 0
    s_cbranch_scc1 A_OV
    ds_read_b128 v[32:35], v229 offset:8320
    ds_read_b128 v[36:39], v229 offset:10880
    s_add_u32 s44, s55, 0x400000
    s_waitcnt lgkmcnt(0)
    buffer_store_dwordx4 v[32:35], v230, s[20:23], s44 offen offset:0 sc1
    buffer_store_dwordx4 v[36:39], v230, s[20:23], s44 offen offset:1024 sc1
    s_branch A_S5
A_OV:
    ds_read_b128 v[32:35], v161 offset:49152
    ds_read_b128 v[36:39], v161 offset:55552
    s_add_u32 s63, s63, 0xd00000
    s_add_u32 s44, s63, 6400
    s_waitcnt lgkmcnt(0)
    buffer_store_dwordx4 v[32:35], v161, s[20:23], s63 offen sc1
    buffer_store_dwordx4 v[36:39], v161, s[20:23], s44 offen sc1
    s_waitcnt vmcnt(0)
    s_branch A_S5
A_RT2:
    s_cmp_eq_u32 s34, 1
    s_cbranch_scc1 A_SY
    s_cmp_eq_u32 s34, 3
    s_mov_b32 s34, 2
    s_cbranch_scc1 A_S2R
    s_endpgm
A_RAW:
    s_lshl_b32 s44, s36, 10
    s_add_u32 s44, s44, 0x1100000
    s_waitcnt lgkmcnt(0)
    buffer_store_dwordx4 v[160:163], v24, s[20:23], s44 offen sc1
    s_add_u32 s44, s44, 8192
    buffer_store_dwordx4 v[164:167], v24, s[20:23], s44 offen sc1
    s_add_u32 s44, s44, 8192
    buffer_store_dwordx4 v[172:175], v24, s[20:23], s44 offen sc1
    s_add_u32 s44, s44, 8192
    buffer_store_dwordx4 v[176:179], v24, s[20:23], s44 offen sc1
    s_add_u32 s44, s44, 8192
    buffer_store_dwordx2 v[168:169], v17, s[20:23], s44 offen sc1
    s_branch A_RAW2
A_CLR:
    s_cmp_eq_u32 s2, 7
    s_cbranch_scc1 A_CL1
    s_lshl_b32 s44, 1, s36
    v_mov_b32 v31, s44
    s_mov_b32 s44, 0xc00008
    s_mov_b64 exec, 1
    buffer_atomic_or v31, off, s[20:23], s44 sc1
    s_mov_b64 exec, -1
    s_branch A_CL2
A_CL1:
    s_cmp_lg_u32 s36, 7
    s_cbranch_scc1 A_CL2
    v_mov_b32 v30, 0
    s_mov_b64 exec, 1
    buffer_store_dword v30, off, s[4:7], 0 sc1
    s_mov_b64 exec, -1
    s_branch A_CL2
A_W6:
    s_mov_b64 exec, -1
    v_mov_b32 v40, 0
    v_mov_b32 v41, 0
    v_mov_b32 v42, 0
    v_mov_b32 v43, 0
    s_mov_b64 s[44:45], 0x3f80
    s_mov_b64 exec, 0xf
    v_lshlrev_b64 v[40:41], v24, s[44:45]
    s_mov_b64 exec, 0xf0
    v_lshlrev_b64 v[42:43], v24, s[44:45]
    s_mov_b64 exec, -1
    s_mov_b32 s44, 40960
    s_movk_i32 s45, 256
    v_writelane_b32 v40, s44, 40
    v_writelane_b32 v41, s45, 36
    v_writelane_b32 v41, s45, 44
    s_mov_b32 s44, 41216
    v_add_u32 v88, 156672, v24
    v_writelane_b32 v41, s44, 40
    ds_write_b128 v88, v[40:43]
    v_mul_u32_u24 v85, 0x20002, v28
    v_add_u32 v85, 0x10000, v85
    v_add_u32 v88, 159872, v84
    s_mov_b64 exec, 15
    ds_write_b32 v88, v85
    s_mov_b64 exec, -1
    s_lshr_b32 s45, s2, 6
    s_lshl_b32 s45, s45, 3
    s_and_b32 s44, s2, 7
    s_add_u32 s45, s45, s44
    s_lshl_b32 s10, 1, s45
    v_and_b32 v88, 7, v28
    s_mov_b32 s44, 155648
    v_lshl_add_u32 v88, v88, 6, s44
    v_lshrrev_b32 v89, 3, v28
    v_lshl_add_u32 v88, v89, 2, v88
    v_add_u32 v89, 156160, v17
    s_cmp_lt_u32 s62, 250
    s_cbranch_scc1 A_S2
    s_branch A_SP1
A_W7:
    s_waitcnt vmcnt(6)
    v_lshlrev_b32 v84, 16, v80
    v_and_b32 v85, 0xffff0000, v80
    v_lshlrev_b32 v86, 16, v81
    v_and_b32 v87, 0xffff0000, v81
    v_maximum3_f32 v80, |v84|, |v85|, |v85|
    ds_write2_b32 v88, v84, v85 offset1:8
    v_and_b32 v80, 0x7fffffff, v80
    ds_write_b64 v89, v[86:87]
    v_mov_b32 v88, 159912
    v_max_u32_dpp v80, v80, v80 quad_perm:[1,0,3,2] row_mask:0xf bank_mask:0xf
    s_nop 1
    v_max_u32_dpp v80, v80, v80 quad_perm:[2,3,0,1] row_mask:0xf bank_mask:0xf
    s_mov_b32 exec_lo, s51
    s_mov_b32 exec_hi, s51
    ds_max_u32 v88, v80
    s_mov_b64 exec, -1
M_H3:
    s_cbranch_execz A_RET
    s_mov_b64 exec, 1
    buffer_load_dword v94, off, s[4:7], 0 sc1
    s_mov_b64 exec, -1
    s_mov_b32 m0, 114688
    s_mov_b32 s38, 32768
    buffer_load_dwordx4 v76, s[24:27], s38 offen offset:0 lds
    buffer_load_dwordx4 v76, s[24:27], s38 offen offset:1024 lds
    buffer_load_dwordx4 v77, s[24:27], s38 offen offset:2048 lds
    buffer_load_dwordx4 v77, s[24:27], s38 offen offset:3072 lds
    s_mov_b64 s[60:61], 0
    s_waitcnt lgkmcnt(0)
    s_cmp_lt_u32 s62, 250
    s_cbranch_scc1 A_S4
    s_branch A_SP2
A_S5:
    s_mov_b64 exec, -1
    v_and_b32 v242, 48, v24
    v_lshrrev_b32 v239, 2, v28
    v_lshl_or_b32 v246, v239, 17, v242
    v_lshl_or_b32 v48, v239, 7, v242
    s_xor_b32 s37, s36, 7
    s_lshl_b32 s49, s37, 14
    s_add_u32 s49, s49, s54
    s_add_u32 s42, s49, 2097152
    s_lshl_b32 s41, s36, 11
    v_mov_b32 v36, 0
    v_mov_b32 v37, 0
    v_mov_b32 v38, 0
    v_mov_b32 v39, 0
    s_add_u32 s52, s41, 122880
    v_add_u32 v49, s52, v24
    v_add_u32 v16, v16, v25
    s_mov_b32 s52, 122880
    v_lshl_add_u32 v16, v16, 4, s52
    v_mul_u32_u24 v247, 1152, v239
    s_mul_i32 s52, s37, 144
    s_add_u32 s52, s52, 73728
    v_add3_u32 v247, s52, v247, v242
    s_lshl_b32 s52, s37, 2
    s_add_u32 s52, s52, 159936
    v_lshl_add_u32 v239, v239, 5, s52
    v_sub_u32 v242, v20, v242
    v_add_u32 v243, 64, v242
    s_mov_b32 s52, 131076
    v_lshl_add_u32 v226, v28, 10, s52
    v_add_u32 v227, 256, v226
    v_mov_b32 v92, 159900
    s_bfe_u32 s44, s2, 0x30003
    s_lshl_b32 s8, s36, 3
    s_waitcnt vmcnt(4)
    v_mfma_f32_16x16x32_bf16 v[44:47], v[56:59], v[56:59], 0
    v_mfma_f32_16x16x32_bf16 v[44:47], v[60:63], v[60:63], v[44:47]
    s_add_u32 s8, s8, s44
    s_mul_i32 s8, s8, 256
    s_add_u32 s8, s8, 0xc00000
    s_mov_b32 s9, 400000
    s_mov_b32 s60, 0xbfb8aa3b
    s_mov_b32 s61, 0xa800000
    s_cmp_lg_u32 s36, 7
    s_cbranch_scc1 A_S6
    s_mov_b64 exec, 1
    v_mul_lo_u32 v90, v94, s10
    v_cmp_ne_u32 vcc, 0, v94
    ds_write_b32 v92, v90
    s_cbranch_vccnz A_S6
    buffer_load_dword v94, off, s[4:7], 0 sc1
A_S6:
    s_mov_b64 exec, -1
    s_nop 0
    v_maximum3_f32 v44, |v44|, |v45|, |v46|
    v_maximum3_f32 v44, |v44|, |v47|, |v47|
    v_and_b32 v44, 0x7fffffff, v44
    v_lshrrev_b32 v44, 24, v44
    v_subrev_u32 v44, 48, v44
    v_med3_i32 v44, v44, 0, 31
    v_lshlrev_b32 v44, v44, 1
    s_mov_b32 exec_lo, 0x00f0000f
    s_mov_b32 exec_hi, 0xf0000f00
    ds_or_b32 v92, v44 offset:4
    s_mov_b64 exec, -1
    s_waitcnt lgkmcnt(0)
    s_barrier
    ds_read2_b32 v[90:91], v92 offset1:1
    ds_read_b64_tr_b16 v[160:161], v64 offset:8192
    ds_read_b64_tr_b16 v[162:163], v64 offset:9216
    ds_read_b64_tr_b16 v[164:165], v64 offset:16384
    ds_read_b64_tr_b16 v[166:167], v64 offset:17408
    ds_read_b64_tr_b16 v[168:169], v14
    ds_read_b64_tr_b16 v[172:173], v64 offset:24576
    ds_read_b64_tr_b16 v[174:175], v64 offset:25600
    ds_read_b64_tr_b16 v[176:177], v64 offset:32768
    ds_read_b64_tr_b16 v[178:179], v64 offset:33792
    s_bitcmp1_b32 238, s36
    s_cselect_b32 s60, s61, s60
    v_add_u32 v31, s47, v17
    v_add_u32 v230, 512, v226
    v_add_u32 v231, 768, v226
    v_mov_b32 v238, 0xfce00000
    v_add_u32 v22, 159936, v24
    v_lshl_add_u32 v50, v26, 3, s37
    v_mul_u32_u24 v255, 102400, v50
    v_and_b32 v51, 15, v28
    v_subrev_u32 v78, 1, v51
    v_mul_u32_u24 v50, 144, v50
    v_lshl_add_u32 v50, v51, 2, v50
    v_add_u32 v254, 73728, v50
    v_or_b32 v78, v78, v29
    s_add_u32 s63, s49, 0x400000
    s_add_u32 s39, s42, 0x400000
    v_and_b32 v50, 24, v17
    s_waitcnt lgkmcnt(7)
    v_lshlrev_b32 v180, 16, v160
    v_and_b32 v181, 0xffff0000, v160
    v_mul_f32 v180, s60, v180
    v_mul_f32 v181, s60, v181
    v_cvt_pk_bf16_f32 v180, v180, v181
    v_lshlrev_b32 v182, 16, v161
    v_and_b32 v183, 0xffff0000, v161
    v_mul_f32 v182, s60, v182
    v_mul_f32 v183, s60, v183
    v_cvt_pk_bf16_f32 v181, v182, v183
    v_lshlrev_b32 v184, 16, v162
    v_and_b32 v185, 0xffff0000, v162
    v_mul_f32 v184, s60, v184
    v_mul_f32 v185, s60, v185
    v_cvt_pk_bf16_f32 v182, v184, v185
    v_lshlrev_b32 v186, 16, v163
    v_and_b32 v187, 0xffff0000, v163
    v_mul_f32 v186, s60, v186
    v_mul_f32 v187, s60, v187
    v_cvt_pk_bf16_f32 v183, v186, v187
    ds_write_b128 v21, v[180:183] offset:2560
    s_waitcnt lgkmcnt(6)
    s_waitcnt vmcnt(0)
    v_cmp_eq_u32 vcc, 0, v90
    s_cbranch_vccnz A_LATE
A_ARR:
    s_mov_b64 exec, 1
    buffer_atomic_or_x2 v[90:91], off, s[20:23], s8 sc1
    s_mov_b64 exec, -1
    s_cmp_eq_u32 s2, 15
    s_cbranch_scc1 A_RAW
    s_sub_u32 s1, s36, 5
    s_cbranch_scc1 A_RAW2
    s_lshr_b32 s53, s2, 3
    s_mul_i32 s53, s53, 3
    s_add_u32 s53, s53, s1
    s_mov_b32 m0, 156416
    s_lshl_b32 s53, s53, 13
    v_lshlrev_b32 v250, 7, v28
    buffer_load_dword v250, s[12:15], s53 offen lds
A_RAW2:
    v_lshlrev_b32 v188, 16, v164
    v_and_b32 v189, 0xffff0000, v164
    v_mul_f32 v188, s60, v188
    v_mul_f32 v189, s60, v189
    v_cvt_pk_bf16_f32 v184, v188, v189
    v_lshlrev_b32 v190, 16, v165
    v_and_b32 v191, 0xffff0000, v165
    v_mul_f32 v190, s60, v190
    v_mul_f32 v191, s60, v191
    v_cvt_pk_bf16_f32 v185, v190, v191
    v_lshlrev_b32 v192, 16, v166
    v_and_b32 v193, 0xffff0000, v166
    v_mul_f32 v192, s60, v192
    v_mul_f32 v193, s60, v193
    v_cvt_pk_bf16_f32 v186, v192, v193
    v_lshlrev_b32 v194, 16, v167
    v_and_b32 v195, 0xffff0000, v167
    v_mul_f32 v194, s60, v194
    v_mul_f32 v195, s60, v195
    v_cvt_pk_bf16_f32 v187, v194, v195
    ds_write_b128 v21, v[184:187] offset:3584
M_H4:
    s_cbranch_execz A_RET
    s_waitcnt lgkmcnt(6)
    v_lshlrev_b32 v196, 16, v168
    v_and_b32 v197, 0xffff0000, v168
    v_mul_f32 v196, s60, v196
    v_mul_f32 v197, s60, v197
    v_cvt_pk_bf16_f32 v188, v196, v197
    v_lshlrev_b32 v198, 16, v169
    v_and_b32 v199, 0xffff0000, v169
    v_mul_f32 v198, s60, v198
    v_mul_f32 v199, s60, v199
    v_cvt_pk_bf16_f32 v189, v198, v199
    ds_write_b64 v31, v[188:189] offset:4608
    s_waitcnt lgkmcnt(3)
    v_mfma_f32_16x16x32_bf16 v[204:207], v[160:163], v[160:163], 0
    v_lshlrev_b32 v82, v50, 8
    v_lshrrev_b32 v50, 1, v50
    v_add_u32 v84, 159872, v50
    v_mfma_f32_16x16x32_bf16 v[204:207], v[164:167], v[164:167], v[204:207]
    s_lshr_b32 s52, s36, 2
    s_mul_i32 s52, s52, 3
    s_xor_b32 s55, s37, s52
    v_mfma_f32_16x16x32_bf16 v[204:207], v[166:169], v[166:169], v[204:207]
    s_and_b32 s11, s2, 7
    s_lshl_b32 s11, s11, 3
    s_add_u32 s11, s11, s36
    v_mfma_f32_16x16x32_bf16 v[204:207], v[172:175], v[172:175], v[204:207]
    s_mul_i32 s11, s11, 256
    s_add_u32 s11, s11, 0xc00000
    s_lshr_b32 s52, s36, 1
    v_mfma_f32_16x16x32_bf16 v[204:207], v[176:179], v[176:179], v[204:207]
    s_lshl_b32 s52, s52, 12
    s_and_b32 s38, s36, 1
    s_lshl_b32 s38, s38, 6
    s_waitcnt lgkmcnt(0)
    s_barrier
    s_add_u32 s38, s52, s38
    ds_read_b64 v[224:225], v17 offset:12800
    s_add_u32 m0, s41, 49152
    ds_read_b64 v[228:229], v17 offset:17920
    s_add_u32 s44, s38, 1024
    ds_read_b64 v[232:233], v17 offset:23040
    buffer_load_dwordx4 v48, s[28:31], s38 offen lds
    ds_read_b64 v[236:237], v17 offset:28160
    buffer_load_dwordx4 v48, s[28:31], s44 offen offset:1024 lds
    ds_read_b64 v[240:241], v17 offset:33280
    v_mov_b32 v14, 159904
    ds_read_b64 v[244:245], v17 offset:38400
    s_mov_b32 s9, 400000
    ds_read_b64 v[248:249], v17 offset:43520
    v_lshlrev_b32 v83, 4, v82
    ds_read_b64 v[252:253], v17 offset:48640
    v_mov_b32 v79, 0x7ffffff0
    ds_read_b128 v[180:183], v24 offset:36352
    v_maximum3_f32 v204, |v204|, |v205|, |v206|
    ds_read_b128 v[184:187], v24 offset:41472
    v_maximum3_f32 v204, |v204|, |v207|, |v207|
    ds_read_b128 v[188:191], v24 offset:46592
    v_and_b32 v204, 0x7fffffff, v204
    ds_read_b128 v[192:195], v24 offset:11776
    s_mov_b64 exec, 1
    buffer_load_dwordx2 v[34:35], off, s[20:23], s11 sc1
    s_mov_b64 exec, -1
    s_mov_b32 exec_lo, 0x00f0000f
    s_mov_b32 exec_hi, 0xf0000f00
    ds_max_u32 v92, v204 offset:8
    s_mov_b64 exec, -1
    ds_read_b128 v[196:199], v24 offset:16896
    ds_write_b128 v21, v[36:39]
    ds_read_b128 v[200:203], v24 offset:22016
    ds_write_b128 v21, v[36:39] offset:1024
    ds_read_b128 v[208:211], v24 offset:32256
    ds_write_b128 v49, v[56:59] offset:0
    ds_read_b128 v[212:215], v24 offset:37376
    ds_write_b128 v49, v[60:63] offset:1024
    ds_read_b128 v[216:219], v24 offset:42496
    v_add_u32 v31, 4294893568, v49
    ds_read_b128 v[220:223], v24 offset:47616
    ds_read_b128 v[160:163], v24 offset:10752
    ds_read_b128 v[164:167], v24 offset:15872
    ds_read_b128 v[168:171], v24 offset:20992
    ds_read_b128 v[172:175], v24 offset:26112
    ds_read_b128 v[176:179], v24 offset:31232
    ds_read_b128 v[204:207], v24 offset:27136
    s_mov_b64 exec, 1
A_POLL:
    s_waitcnt vmcnt(0)
    v_cmp_ne_u32 vcc, -1, v34
    s_cbranch_vccz A_GO
    buffer_load_dwordx2 v[34:35], off, s[20:23], s11 sc1
    s_sub_u32 s9, s9, 1
    s_cmp_lg_u32 s9, 0
    s_cbranch_scc1 A_POLL
    ds_write_b32 v14, v14 offset:12
A_GO:
    s_mov_b64 exec, -1
    buffer_load_dwordx4 v[88:91], v246, s[20:23], s49 offen sc1
    buffer_load_dwordx4 v[92:95], v246, s[20:23], s42 offen sc1
    s_mov_b64 exec, 1
    ds_or_b32 v14, v35
    s_mov_b64 exec, -1
    ds_read_b64_tr_b16 v[96:97], v65 offset:24576
    ds_read_b64_tr_b16 v[98:99], v65 offset:25600
    ds_read_b64_tr_b16 v[100:101], v66 offset:24576
    ds_read_b64_tr_b16 v[102:103], v66 offset:25600
    ds_read_b64_tr_b16 v[104:105], v67 offset:24576
    ds_read_b64_tr_b16 v[106:107], v67 offset:25600
    ds_read_b64_tr_b16 v[108:109], v68 offset:24576
    ds_read_b64_tr_b16 v[110:111], v68 offset:25600
    ds_read_b64_tr_b16 v[112:113], v69 offset:24576
    ds_read_b64_tr_b16 v[114:115], v69 offset:25600
    ds_read_b64_tr_b16 v[116:117], v70 offset:24576
    ds_read_b64_tr_b16 v[118:119], v70 offset:25600
    ds_read_b64_tr_b16 v[120:121], v71 offset:24576
    ds_read_b64_tr_b16 v[122:123], v71 offset:25600
    ds_read_b64_tr_b16 v[124:125], v72 offset:24576
    ds_read_b64_tr_b16 v[126:127], v72 offset:25600
    ds_read_b64_tr_b16 v[128:129], v65 offset:32768
    ds_read_b64_tr_b16 v[130:131], v65 offset:33792
    ds_read_b64_tr_b16 v[132:133], v66 offset:32768
    ds_read_b64_tr_b16 v[134:135], v66 offset:33792
    ds_read_b64_tr_b16 v[136:137], v67 offset:32768
    ds_read_b64_tr_b16 v[138:139], v67 offset:33792
    ds_read_b64_tr_b16 v[140:141], v68 offset:32768
    ds_read_b64_tr_b16 v[142:143], v68 offset:33792
    ds_read_b64_tr_b16 v[144:145], v69 offset:32768
    ds_read_b64_tr_b16 v[146:147], v69 offset:33792
    ds_read_b64_tr_b16 v[148:149], v70 offset:32768
    ds_read_b64_tr_b16 v[150:151], v70 offset:33792
    ds_read_b64_tr_b16 v[152:153], v71 offset:32768
    ds_read_b64_tr_b16 v[154:155], v71 offset:33792
    ds_read_b64_tr_b16 v[156:157], v72 offset:32768
    ds_read_b64_tr_b16 v[158:159], v72 offset:33792
    s_waitcnt vmcnt(3)
    ds_read_b64_tr_b16 v[40:41], v31 offset:0
    ds_read_b64_tr_b16 v[42:43], v31 offset:1024
    ds_read_b64_tr_b16 v[44:45], v31 offset:8
    ds_read_b64_tr_b16 v[46:47], v31 offset:1032
    s_waitcnt lgkmcnt(2)
    ds_write_b128 v31, v[40:43] offset:0
    s_waitcnt lgkmcnt(1)
    ds_write_b128 v31, v[44:47] offset:1024
    s_cmp_ge_u32 s36, 4
    s_cbranch_scc1 A_SY
    s_lshl_b32 s35, s36, 2
    s_lshr_b32 s35, 0xfb87, s35
    s_mov_b32 s34, 1
    s_branch A_HOP
A_SY:
    s_mov_b32 s34, 0x30d400
    s_mov_b32 s35, 0x20000
    s_waitcnt vmcnt(1)
    v_mov_b32_dpp v234, v88 quad_perm:[0,0,0,0] row_mask:0xf bank_mask:0xf
    ds_write_b128 v247, v[88:91] offset:0
M_H5:
    s_cbranch_execz A_RET
    ds_read_b32 v48, v254
    v_dot8_u32_u4 v85, v234, v82, 0
    v_dot8_u32_u4 v86, v234, v83, 0
    v_dot8_u32_u4 v80, v234, s51, 0
    ds_write_b32 v239, v234 offset:0
    s_waitcnt vmcnt(0)
    v_mov_b32_dpp v235, v92 quad_perm:[0,0,0,0] row_mask:0xf bank_mask:0xf
    ds_write_b128 v247, v[92:95] offset:18432
    v_dot8_u32_u4 v85, v235, v82, v85
    v_dot8_u32_u4 v86, v235, v83, v86
    v_dot8_u32_u4 v81, v235, s51, 0
    ds_write_b32 v239, v235 offset:512
    s_mov_b32 s44, 0xf000f000
    v_lshl_or_b32 v85, v86, 16, v85
    v_cmp_lt_u32 s[58:59], 15, v80
    v_cmp_lt_u32 s[60:61], 15, v81
    v_add_u32_dpp v85, v85, v85 row_shr:4 row_mask:0xf bank_mask:0xf
    v_max_u32 v30, v80, v81
    s_mov_b32 s45, s44
    v_add_u32_dpp v85, v85, v85 row_shr:8 row_mask:0xf bank_mask:0xf
    s_mov_b64 exec, s[44:45]
    ds_add_u32 v84, v85
    s_mov_b64 exec, -1
    v_cmp_lt_u32 vcc, 31, v30
    s_mov_b64 exec, s[58:59]
    s_cbranch_execz M_NOB0
    buffer_load_dwordx4 v[64:67], v246, s[20:23], s63 offen sc1
M_NOB0:
    s_mov_b64 exec, s[60:61]
    s_cbranch_execz M_NOB1
    buffer_load_dwordx4 v[68:71], v246, s[20:23], s39 offen sc1
M_NOB1:
    s_cbranch_vccz M_NOC
    s_and_b32 exec_lo, vcc_lo, s51
    s_and_b32 exec_hi, vcc_hi, s51
    s_add_u32 s44, s63, 0x400000
    s_add_u32 s45, s39, 0x400000
    buffer_load_dwordx4 v[88:91], v246, s[20:23], s44 offen sc1
    buffer_load_dwordx4 v[92:95], v246, s[20:23], s45 offen sc1
    s_waitcnt vmcnt(0)
    ds_write_b128 v247, v[88:91] offset:128
    ds_write_b128 v247, v[92:95] offset:18560
M_NOC:
    s_mov_b64 exec, -1
    s_waitcnt lgkmcnt(4)
    v_mov_b32_dpp v50, v48 row_newbcast:0 row_mask:0xf bank_mask:0xf
    s_mov_b32 m0, 156416
    v_dot8_u32_u4 v50, v50, s51, 0
    s_nop 0
    v_bfe_u32 v48, v48, 16, 12
    v_lshl_add_u32 v48, v48, 5, v255
    v_cmp_lt_u32 vcc, v78, v50
    s_waitcnt lgkmcnt(0)
    s_barrier
    v_cndmask_b32 v48, v79, v48, vcc
    buffer_load_dword v48, s[16:19], 0 offen lds
    ds_read_u16 v76, v18
    ds_read_u16 v77, v19
    ds_read_b128 v[32:35], v22
    ds_read_b32 v74, v14 offset:12
    s_waitcnt lgkmcnt(2)
    v_cmp_lt_u32 vcc, v76, v77
    s_nop 1
    v_lshrrev_b64 v[72:73], v17, vcc
    v_and_b32 v72, 0xff, v72
    v_bcnt_u32_b32 v72, v72, 0
    v_cmp_eq_u32 vcc, s55, v72
    s_nop 0
    s_ff1_i32_b32 s37, vcc_lo
    s_lshl_b32 s49, s37, 2
    s_lshl_b32 s53, 4, s49
    s_bfm_b32 s52, s49, 0
    s_and_b32 s52, s52, 0x44444444
    s_waitcnt lgkmcnt(0)
    v_cmp_ne_u32 vcc, 0, v74
    v_dot8_u32_u4 v80, v32, s53, 0
    v_dot8_u32_u4 v81, v33, s53, 0
    v_dot8_u32_u4 v82, v34, s53, 0
    v_dot8_u32_u4 v83, v35, s53, 0
    s_cbranch_vccnz M_END
    v_lshl_add_u32 v16, s37, 11, v16
    v_max3_u32 v92, v32, v33, v34
    v_max_u32 v92, v92, v35
    v_cmp_eq_u32 vcc, -1, v92
    ds_read_b128 v[56:59], v16 offset:0
    ds_read_b128 v[60:63], v16 offset:1024
    v_add_u32 v86, v80, v81
    v_add_u32 v87, v86, v82
    v_add_u32 v92, v87, v83
    v_mov_b32 v93, v92
    s_cbranch_vccnz M_GEN
    v_subrev_u32 v92, s47, v92
    s_nop 0
    v_add_u32_dpp v93, v93, v93 row_shr:1 row_mask:0xf bank_mask:0xf
    s_nop 1
    v_add_u32_dpp v93, v93, v93 row_shr:2 row_mask:0xf bank_mask:0xf
    v_dot8_u32_u4 v36, v32, s52, v226
    v_dot8_u32_u4 v37, v33, s52, v227
    v_add_u32_dpp v93, v93, v93 row_shr:4 row_mask:0xf bank_mask:0xf
    v_dot8_u32_u4 v38, v34, s52, v230
    v_dot8_u32_u4 v39, v35, s52, v231
    v_add_u32_dpp v93, v93, v93 row_shr:8 row_mask:0xf bank_mask:0xf
    s_nop 1
    v_add_u32_dpp v93, v93, v93 row_bcast:15 row_mask:0xa bank_mask:0xf
    s_nop 1
    v_add_u32_dpp v93, v93, v93 row_bcast:31 row_mask:0xc bank_mask:0xf
    v_sub_u32 v84, v93, v92
    v_readlane_b32 s41, v93, 63
    v_add_u32 v85, v84, v80
    v_add_u32 v86, v84, v86
    v_add_u32 v87, v84, v87
    v_sub_u32 v88, v36, v84
    v_min_u32 v84, s50, v84
    ds_max_u32 v84, v88
    v_sub_u32 v89, v37, v85
    v_min_u32 v85, s50, v85
    ds_max_u32 v85, v89
    v_sub_u32 v90, v38, v86
    v_min_u32 v86, s50, v86
    ds_max_u32 v86, v90
    v_sub_u32 v91, v39, v87
    v_min_u32 v87, s50, v87
    ds_max_u32 v87, v91
    ds_read_b128 v[40:43], v242
    ds_read_b128 v[44:47], v242 offset:64
    v_mov_b32 v81, 0
    v_mov_b32 v84, 0
    s_mov_b32 s31, 0
    s_add_u32 s44, s3, s37
    s_lshl_b32 s45, s44, 13
    s_add_u32 s45, s45, 670
    s_mul_hi_u32 s38, s45, s46
    s_lshr_b32 s38, s38, 9
    s_add_u32 s44, s44, 1
    s_lshl_b32 s45, s44, 13
    s_add_u32 s45, s45, 670
    s_mul_hi_u32 s39, s45, s46
    s_lshr_b32 s39, s39, 9
    s_min_u32 s39, s39, 25000
    s_mov_b32 s56, 0
    s_sub_u32 s42, s41, s40
    s_min_u32 s42, s42, 2048
    s_sub_u32 s62, s42, 4
    s_or_b32 s62, s62, s31
    s_bitcmp0_b32 s62, 6
    s_cselect_b32 s62, 1, 0
    s_add_u32 s42, s42, 127
    s_lshr_b32 s42, s42, 7
    s_mov_b32 s45, 196356
    s_movk_i32 s44, -112
    s_waitcnt lgkmcnt(0)
    v_max_u32 v41, v41, v40
    v_max_u32 v45, v45, v44
    v_max_u32 v42, v42, v41
    v_max_u32 v46, v46, v45
    v_max_u32 v43, v43, v42
    v_max_u32 v47, v47, v46
    v_max_u32 v93, v43, v47
    s_nop 1
    v_max_u32_dpp v93, v93, v93 row_shr:1 row_mask:0xf bank_mask:0xf
    v_max_u32_dpp v84, v43, v84 row_shr:1 row_mask:0xf bank_mask:0xf
    v_max_u32_dpp v85, v43, v43 quad_perm:[1,0,3,2] row_mask:0xf bank_mask:0xf
    v_max_u32_dpp v93, v93, v93 row_shr:2 row_mask:0xf bank_mask:0xf
    v_max_u32_dpp v84, v43, v84 row_shr:2 row_mask:0xf bank_mask:0xf
    v_max_u32_dpp v85, v85, v85 quad_perm:[2,3,0,1] row_mask:0xf bank_mask:0xf
    v_max_u32_dpp v93, v93, v93 row_shr:4 row_mask:0xf bank_mask:0xf
    v_max_u32_dpp v84, v43, v84 row_shr:3 row_mask:0xf bank_mask:0xf
    s_nop 0
    v_max_u32_dpp v93, v93, v93 row_shr:8 row_mask:0xf bank_mask:0xf
    s_nop 1
    v_max_u32_dpp v93, v93, v93 row_bcast:15 row_mask:0xa bank_mask:0xf
    s_nop 1
    v_max_u32_dpp v93, v93, v93 row_bcast:31 row_mask:0xc bank_mask:0xf
    s_nop 1
    v_mov_b32_dpp v81, v93 wave_shr:1 row_mask:0xf bank_mask:0xf
M_H6:
    s_cbranch_execz A_RET
    v_max_u32 v85, v85, v81
    v_max_u32 v44, v44, v85
    v_add3_u32 v44, v44, v243, 0
    v_min_u32 v44, s45, v44
    v_lshrrev_b32 v36, 8, v44
    v_mad_i32_i24 v44, v36, s44, v44
    v_max_u32_dpp v84, v81, v84 quad_perm:[0,0,0,0] row_mask:0xf bank_mask:0xf
    v_max_u32 v45, v45, v85
    v_add3_u32 v45, v45, v243, 4
    v_min_u32 v45, s45, v45
    v_lshrrev_b32 v37, 8, v45
    v_mad_i32_i24 v45, v37, s44, v45
    v_max_u32 v46, v46, v85
    v_add3_u32 v46, v46, v243, 8
    v_min_u32 v46, s45, v46
    v_lshrrev_b32 v38, 8, v46
    v_mad_i32_i24 v46, v38, s44, v46
    v_max_u32 v47, v47, v85
    v_add3_u32 v47, v47, v243, 12
    v_min_u32 v47, s45, v47
    v_lshrrev_b32 v39, 8, v47
    v_mad_i32_i24 v47, v39, s44, v47
    v_max_u32 v40, v40, v84
    v_add3_u32 v40, v40, v242, 0
    v_min_u32 v40, s45, v40
    v_lshrrev_b32 v32, 8, v40
    v_mad_i32_i24 v40, v32, s44, v40
    v_max_u32 v41, v41, v84
    v_add3_u32 v41, v41, v242, 4
    v_min_u32 v41, s45, v41
    v_lshrrev_b32 v33, 8, v41
    v_mad_i32_i24 v41, v33, s44, v41
    v_max_u32 v42, v42, v84
    v_add3_u32 v42, v42, v242, 8
    v_min_u32 v42, s45, v42
    v_lshrrev_b32 v34, 8, v42
    v_mad_i32_i24 v42, v34, s44, v42
    v_max_u32 v43, v43, v84
    v_add3_u32 v43, v43, v242, 12
    v_min_u32 v43, s45, v43
    v_lshrrev_b32 v35, 8, v43
    v_mad_i32_i24 v43, v35, s44, v43
    s_waitcnt vmcnt(1)
    ds_write_b128 v247, v[64:67] offset:64
    ds_write_b128 v247, v[68:71] offset:18496
    s_waitcnt lgkmcnt(0)
    s_barrier
    ds_read_b32 v48, v40 offset:0
    ds_read_b32 v49, v41 offset:0
    ds_read_b32 v50, v44 offset:0
    ds_read_b32 v51, v45 offset:0
    ds_read_b32 v52, v42 offset:0
    ds_read_b32 v53, v43 offset:0
    ds_read_b32 v54, v46 offset:0
    ds_read_b32 v55, v47 offset:0
    s_mov_b32 s45, 102400
    v_mad_u32_u24 v64, v32, s45, v238
    v_mad_u32_u24 v65, v33, s45, v238
    v_mad_u32_u24 v66, v36, s45, v238
    v_mad_u32_u24 v67, v37, s45, v238
    v_mad_u32_u24 v68, v34, s45, v238
    v_mad_u32_u24 v69, v35, s45, v238
    v_mad_u32_u24 v70, v38, s45, v238
    v_mad_u32_u24 v71, v39, s45, v238
M_LST:
    s_waitcnt lgkmcnt(0)
    v_lshlrev_b32_sdwa v80, 6, v48 dst_sel:DWORD dst_unused:UNUSED_PAD src0_sel:DWORD src1_sel:WORD_0
    v_lshlrev_b32_sdwa v81, 6, v49 dst_sel:DWORD dst_unused:UNUSED_PAD src0_sel:DWORD src1_sel:WORD_0
    v_lshlrev_b32_sdwa v82, 6, v50 dst_sel:DWORD dst_unused:UNUSED_PAD src0_sel:DWORD src1_sel:WORD_0
    v_lshlrev_b32_sdwa v83, 6, v51 dst_sel:DWORD dst_unused:UNUSED_PAD src0_sel:DWORD src1_sel:WORD_0
    ds_write_b128 v20, v[80:83] offset:0
    v_lshlrev_b32_sdwa v84, 6, v52 dst_sel:DWORD dst_unused:UNUSED_PAD src0_sel:DWORD src1_sel:WORD_0
    v_lshlrev_b32_sdwa v85, 6, v53 dst_sel:DWORD dst_unused:UNUSED_PAD src0_sel:DWORD src1_sel:WORD_0
    v_lshlrev_b32_sdwa v86, 6, v54 dst_sel:DWORD dst_unused:UNUSED_PAD src0_sel:DWORD src1_sel:WORD_0
    v_lshlrev_b32_sdwa v87, 6, v55 dst_sel:DWORD dst_unused:UNUSED_PAD src0_sel:DWORD src1_sel:WORD_0
    ds_write_b128 v20, v[84:87] offset:16
    ds_read_b128 v[16:19], v6 offset:0
    s_barrier
    v_bfe_u32 v88, v48, 16, 12
    v_lshl_add_u32 v88, v88, 5, v64
    v_bfe_u32 v89, v49, 16, 12
    v_lshl_add_u32 v89, v89, 5, v65
    v_bfe_u32 v90, v50, 16, 12
    v_lshl_add_u32 v90, v90, 5, v66
    v_bfe_u32 v91, v51, 16, 12
    v_lshl_add_u32 v91, v91, 5, v67
    ds_write_b128 v20, v[88:91] offset:2048
    v_bfe_u32 v92, v52, 16, 12
    v_lshl_add_u32 v92, v92, 5, v68
    v_bfe_u32 v93, v53, 16, 12
    v_lshl_add_u32 v93, v93, 5, v69
    v_bfe_u32 v94, v54, 16, 12
    v_lshl_add_u32 v94, v94, 5, v70
    v_bfe_u32 v95, v55, 16, 12
    v_lshl_add_u32 v95, v95, 5, v71
    ds_write_b128 v20, v[92:95] offset:2064
    ds_read_b32 v11, v7 offset:0
    ds_read_b128 v[24:27], v6 offset:128
    ds_read_b32 v32, v7 offset:128
    s_waitcnt lgkmcnt(5)
    v_add_u32 v16, v16, v2
    v_xad_u32 v17, v2, 64, v17
    v_add_u32 v18, v18, v2
    v_xad_u32 v19, v2, 64, v19
    s_waitcnt lgkmcnt(2)
    v_add_u32 v11, v11, v3
    s_cmp_lt_u32 s36, 4
    s_cbranch_scc0 M_Y0
    s_add_u32 m0, s43, 0
    s_nop 0
    buffer_load_dwordx4 v16, s[12:15], 0 offen lds
    s_add_u32 m0, s43, 1024
    s_nop 0
    buffer_load_dwordx4 v17, s[12:15], 0 offen lds
    s_add_u32 m0, s43, 2048
    s_nop 0
    buffer_load_dwordx4 v18, s[12:15], 0 offen lds
    s_add_u32 m0, s43, 3072
    s_nop 0
    buffer_load_dwordx4 v19, s[12:15], 0 offen lds
    s_add_u32 m0, s43, 4096
    s_nop 0
    buffer_load_dwordx4 v11, s[16:19], 0 offen lds
M_Y0:
    s_mov_b32 s44, 0x04070003
    v_perm_b32 v72, v49, v48, s44
    v_and_b32 v72, 0x01f001f0, v72
    v_perm_b32 v73, v51, v50, s44
    v_and_b32 v73, 0x01f001f0, v73
    v_perm_b32 v74, v53, v52, s44
    v_and_b32 v74, 0x01f001f0, v74
    v_perm_b32 v75, v55, v54, s44
    v_and_b32 v75, 0x01f001f0, v75
    ds_write_b128 v21, v[72:75] offset:4096
    ds_read_u16 v12, v9 offset:0
    ds_read_u16 v13, v9 offset:4
    ds_read_b32 v14, v8 offset:0
    ds_read_b128 v[40:43], v23 offset:0
    ds_read_b128 v[44:47], v23 offset:16
    s_mov_b32 s60, 0xbfb8aa3b
    s_mov_b32 s61, 0xa800000
    s_waitcnt lgkmcnt(6)
    v_add_u32 v24, v24, v2
    v_xad_u32 v25, v2, 64, v25
    v_add_u32 v26, v26, v2
    v_xad_u32 v27, v2, 64, v27
    v_add_u32 v32, v32, v3
    s_waitcnt lgkmcnt(0)
    v_xad_u32 v12, v12, v29, v5
    v_xad_u32 v13, v13, v29, v5
    v_xor_b32_sdwa v15, v4, v14 dst_sel:DWORD dst_unused:UNUSED_PAD src0_sel:DWORD src1_sel:WORD_1
    v_xor_b32_sdwa v14, v4, v14 dst_sel:DWORD dst_unused:UNUSED_PAD src0_sel:DWORD src1_sel:WORD_0
    ds_read_b64_tr_b16 v[20:21], v14
    ds_read_b64_tr_b16 v[22:23], v15
M_H7:
    s_cbranch_execz A_RET
    s_cmp_lt_u32 s36, 4
    s_cbranch_scc1 M_Y1
    s_add_u32 m0, s43, 0
    s_nop 0
    buffer_load_dwordx4 v16, s[12:15], 0 offen lds
    s_add_u32 m0, s43, 1024
    s_nop 0
    buffer_load_dwordx4 v17, s[12:15], 0 offen lds
    s_add_u32 m0, s43, 2048
    s_nop 0
    buffer_load_dwordx4 v18, s[12:15], 0 offen lds
    s_add_u32 m0, s43, 3072
    s_nop 0
    buffer_load_dwordx4 v19, s[12:15], 0 offen lds
    s_add_u32 m0, s43, 4096
    s_nop 0
    buffer_load_dwordx4 v11, s[16:19], 0 offen lds
M_Y1:
    ds_read_b128 v[16:19], v6 offset:256
    ds_read_b32 v11, v7 offset:256
    v_mfma_f32_16x16x32_bf16 v[64:67], v[56:59], v[96:99], 0
    v_mul_f32 v40, s60, v40
    v_mfma_f32_16x16x32_bf16 v[68:71], v[56:59], v[100:103], 0
    v_mul_f32 v41, s61, v41
    v_mfma_f32_16x16x32_bf16 v[72:75], v[56:59], v[104:107], 0
    v_mul_f32 v42, s61, v42
    v_mfma_f32_16x16x32_bf16 v[76:79], v[56:59], v[108:111], 0
    v_mul_f32 v43, s61, v43
    v_mfma_f32_16x16x32_bf16 v[80:83], v[56:59], v[112:115], 0
    v_mul_f32 v44, s60, v44
    v_mfma_f32_16x16x32_bf16 v[84:87], v[56:59], v[116:119], 0
    v_mul_f32 v45, s61, v45
    v_mfma_f32_16x16x32_bf16 v[88:91], v[56:59], v[120:123], 0
    v_mul_f32 v46, s61, v46
    v_mfma_f32_16x16x32_bf16 v[92:95], v[56:59], v[124:127], 0
    v_mul_f32 v47, s61, v47
    v_mfma_f32_16x16x32_bf16 v[64:67], v[60:63], v[128:131], v[64:67]
    v_mov_b32 v36, 0
    v_mfma_f32_16x16x32_bf16 v[68:71], v[60:63], v[132:135], v[68:71]
    v_mov_b32 v37, 0
    v_mfma_f32_16x16x32_bf16 v[72:75], v[60:63], v[136:139], v[72:75]
    v_mov_b32 v38, 0
    v_mfma_f32_16x16x32_bf16 v[76:79], v[60:63], v[140:143], v[76:79]
    v_mov_b32 v39, 0
    v_mfma_f32_16x16x32_bf16 v[80:83], v[60:63], v[144:147], v[80:83]
    v_mfma_f32_16x16x32_bf16 v[84:87], v[60:63], v[148:151], v[84:87]
    v_mfma_f32_16x16x32_bf16 v[88:91], v[60:63], v[152:155], v[88:91]
    v_mfma_f32_16x16x32_bf16 v[92:95], v[60:63], v[156:159], v[92:95]
    v_mfma_f32_32x32x16_bf16 v[128:143], v[36:39], v[36:39], 0
    v_lshl_add_u32 v31, v28, 4, s47
    ds_read_b128 v[116:119], v31 offset:4096
    v_and_b32 v31, 3, v28
    v_lshl_add_u32 v31, v31, 2, s48
    v_mov_b32 v30, 1
    v_mov_b32 v100, 159904
    ds_read_b128 v[96:99], v100
    v_fma_f32 v64, v64, s60, v40
    v_fma_f32 v65, v65, s60, v40
    v_fma_f32 v66, v66, s60, v40
    v_fma_f32 v67, v67, s60, v40
    v_cvt_pk_bf16_f32 v226, v64, v65
    v_cvt_pk_bf16_f32 v227, v66, v67
    v_fma_f32 v68, v68, s61, v41
    v_fma_f32 v69, v69, s61, v41
    s_waitcnt lgkmcnt(0)
    v_add_u32 v16, v16, v2
    v_xad_u32 v17, v2, 64, v17
    v_add_u32 v18, v18, v2
    v_xad_u32 v19, v2, 64, v19
    v_add_u32 v11, v11, v3
    v_fma_f32 v70, v70, s61, v41
    v_fma_f32 v71, v71, s61, v41
    v_permlane32_swap_b32 v224, v226
    v_permlane32_swap_b32 v225, v227
    v_add_u32_sdwa v120, v31, v116 dst_sel:DWORD dst_unused:UNUSED_PAD src0_sel:DWORD src1_sel:WORD_0
    ds_add_u32 v120, v30
    v_cvt_pk_bf16_f32 v230, v68, v69
    v_cvt_pk_bf16_f32 v231, v70, v71
    v_mfma_f32_32x32x16_bf16 v[144:159], v[36:39], v[36:39], 0
    v_fma_f32 v72, v72, s61, v42
    v_fma_f32 v73, v73, s61, v42
    v_fma_f32 v74, v74, s61, v42
    v_add_u32_sdwa v121, v31, v116 dst_sel:DWORD dst_unused:UNUSED_PAD src0_sel:DWORD src1_sel:WORD_1
    ds_add_u32 v121, v30
    v_fma_f32 v75, v75, s61, v42
    v_permlane32_swap_b32 v228, v230
    v_permlane32_swap_b32 v229, v231
    v_cvt_pk_bf16_f32 v234, v72, v73
    v_cvt_pk_bf16_f32 v235, v74, v75
    v_fma_f32 v76, v76, s61, v43
    v_add_u32_sdwa v122, v31, v117 dst_sel:DWORD dst_unused:UNUSED_PAD src0_sel:DWORD src1_sel:WORD_0
    ds_add_u32 v122, v30
    s_add_u32 m0, s43, 40960
    v_fma_f32 v77, v77, s61, v43
    buffer_load_dwordx4 v24, s[12:15], 0 offen lds
    v_fma_f32 v78, v78, s61, v43
    v_fma_f32 v79, v79, s61, v43
    v_permlane32_swap_b32 v232, v234
    v_permlane32_swap_b32 v233, v235
    v_cvt_pk_bf16_f32 v238, v76, v77
    v_add_u32_sdwa v123, v31, v117 dst_sel:DWORD dst_unused:UNUSED_PAD src0_sel:DWORD src1_sel:WORD_1
    ds_add_u32 v123, v30
    v_cvt_pk_bf16_f32 v239, v78, v79
    v_fma_f32 v80, v80, s60, v44
    s_add_u32 m0, s43, 41984
    v_fma_f32 v81, v81, s60, v44
    buffer_load_dwordx4 v25, s[12:15], 0 offen lds
    v_fma_f32 v82, v82, s60, v44
    v_fma_f32 v83, v83, s60, v44
    v_permlane32_swap_b32 v236, v238
    v_add_u32_sdwa v124, v31, v118 dst_sel:DWORD dst_unused:UNUSED_PAD src0_sel:DWORD src1_sel:WORD_0
    ds_add_u32 v124, v30
    v_permlane32_swap_b32 v237, v239
    v_cvt_pk_bf16_f32 v242, v80, v81
    v_cvt_pk_bf16_f32 v243, v82, v83
    v_fma_f32 v84, v84, s61, v45
    s_add_u32 m0, s43, 43008
    v_fma_f32 v85, v85, s61, v45
    buffer_load_dwordx4 v26, s[12:15], 0 offen lds
    v_fma_f32 v86, v86, s61, v45
    v_add_u32_sdwa v125, v31, v118 dst_sel:DWORD dst_unused:UNUSED_PAD src0_sel:DWORD src1_sel:WORD_1
    ds_add_u32 v125, v30
    v_fma_f32 v87, v87, s61, v45
    v_permlane32_swap_b32 v240, v242
    v_permlane32_swap_b32 v241, v243
    v_cvt_pk_bf16_f32 v246, v84, v85
    v_cvt_pk_bf16_f32 v247, v86, v87
    v_fma_f32 v88, v88, s61, v46
    v_add_u32_sdwa v126, v31, v119 dst_sel:DWORD dst_unused:UNUSED_PAD src0_sel:DWORD src1_sel:WORD_0
    ds_add_u32 v126, v30
    s_add_u32 m0, s43, 44032
    v_fma_f32 v89, v89, s61, v46
    buffer_load_dwordx4 v27, s[12:15], 0 offen lds
    v_fma_f32 v90, v90, s61, v46
    v_fma_f32 v91, v91, s61, v46
    v_permlane32_swap_b32 v244, v246
    v_permlane32_swap_b32 v245, v247
    v_cvt_pk_bf16_f32 v250, v88, v89
    v_add_u32_sdwa v127, v31, v119 dst_sel:DWORD dst_unused:UNUSED_PAD src0_sel:DWORD src1_sel:WORD_1
    ds_add_u32 v127, v30
    v_cvt_pk_bf16_f32 v251, v90, v91
    v_fma_f32 v92, v92, s61, v47
    s_add_u32 m0, s43, 45056
    v_fma_f32 v93, v93, s61, v47
    buffer_load_dwordx4 v32, s[16:19], 0 offen lds
    v_fma_f32 v94, v94, s61, v47
    v_fma_f32 v95, v95, s61, v47
M_H8:
    s_cbranch_execz A_RET
    v_permlane32_swap_b32 v248, v250
    v_permlane32_swap_b32 v249, v251
    v_cvt_pk_bf16_f32 v254, v92, v93
    v_cvt_pk_bf16_f32 v255, v94, v95
    s_nop 0
    v_permlane32_swap_b32 v252, v254
    v_permlane32_swap_b32 v253, v255
    v_ffbh_u32 v96, v96
    v_rcp_f32 v100, v97
    v_sub_u32 v101, 144, v96
    v_sqrt_f32 v97, v97
    v_lshlrev_b32 v101, 23, v101
    v_cmp_ne_u32 s[44:45], 0, v96
    v_fmac_f32 v98, v97, v101
    v_mul_f32 v100, 0x49742400, v100
    v_cmp_gt_f32 vcc, 0x447a0000, v98
    v_readfirstlane_b32 s63, v100
    s_nop 0
    s_and_b64 vcc, vcc, s[44:45]
    s_cselect_b32 s63, s63, 0
    s_or_b32 s44, s2, 8
    s_cmp_eq_u32 s44, 15
    s_cbranch_scc1 A_CLR
A_CL2:
    s_cmp_eq_u32 s42, 0
    s_cbranch_scc1 M_EPI0
    v_bfe_u32 v25, v28, 1, 3
    v_lshrrev_b32 v31, 4, v28
    v_lshlrev_b32 v26, 1, v31
    v_sub_u32 v25, v25, v26
    v_lshlrev_b32 v24, 4, v28
    v_cmp_eq_u32 vcc, 0, v25
    v_cmp_eq_u32 s[58:59], 1, v25
    v_mov_b32 v26, 0x3f80
    v_lshlrev_b32 v30, v24, v26
    v_cndmask_b32 v76, 0, v30, vcc
    v_cndmask_b32 v77, 0, v30, s[58:59]
    v_mov_b32 v78, 0
    v_mov_b32 v79, 0
    v_and_b32 v30, 15, v28
    v_lshl_add_u32 v25, v30, 4, s48
    s_mov_b32 s44, 156160
    v_lshl_add_u32 v26, v31, 5, s44
    v_subrev_u32 v30, s38, v30
    v_and_b32 v30, 15, v30
    v_add_u32 v30, s38, v30
    v_cmp_gt_u32 vcc, s39, v30
    v_lshlrev_b32 v30, 7, v30
    v_lshl_add_u32 v30, v31, 4, v30
    v_mov_b32 v31, 0x7fffff00
    v_cndmask_b32 v27, v31, v30, vcc
    s_waitcnt vmcnt(5)
    ds_read_b128 v[56:59], v0 offset:0
    ds_read_b128 v[60:63], v0 offset:2048
    ds_read_b128 v[64:67], v1 offset:0
    ds_read_b128 v[68:71], v1 offset:2048
    ds_read_b128 v[48:51], v12
    ds_read_b128 v[52:55], v13
    s_waitcnt lgkmcnt(5)
    v_mfma_f32_16x16x32_bf16 v[96:99], v[56:59], v[160:163], 0
    v_mfma_f32_16x16x32_bf16 v[104:107], v[56:59], v[164:167], 0
    s_waitcnt lgkmcnt(4)
    v_mfma_f32_16x16x32_bf16 v[100:103], v[60:63], v[160:163], 0
    v_mfma_f32_16x16x32_bf16 v[108:111], v[60:63], v[164:167], 0
    s_waitcnt lgkmcnt(3)
    v_mfma_f32_16x16x32_bf16 v[96:99], v[64:67], v[192:195], v[96:99]
    v_mfma_f32_16x16x32_bf16 v[104:107], v[64:67], v[196:199], v[104:107]
    s_waitcnt lgkmcnt(2)
    v_mfma_f32_16x16x32_bf16 v[100:103], v[68:71], v[192:195], v[100:103]
    v_mfma_f32_16x16x32_bf16 v[108:111], v[68:71], v[196:199], v[108:111]
    s_waitcnt lgkmcnt(1)
    v_mfma_f32_16x16x32_bf16 v[96:99], v[48:51], v[224:227], v[96:99]
    v_mfma_f32_16x16x32_bf16 v[104:107], v[48:51], v[228:231], v[104:107]
    s_waitcnt lgkmcnt(0)
    v_mfma_f32_16x16x32_bf16 v[100:103], v[52:55], v[224:227], v[100:103]
    v_mfma_f32_16x16x32_bf16 v[108:111], v[52:55], v[228:231], v[108:111]
    s_setprio 1
    s_lshr_b32 vcc_lo, s36, 2
    s_mov_b32 vcc_hi, 0
    s_nop 2
    v_mfma_f32_16x16x32_bf16 v[112:115], v[56:59], v[168:171], 0
    v_exp_f32 v80, v96
    v_exp_f32 v81, v97
    v_mfma_f32_16x16x32_bf16 v[120:123], v[56:59], v[172:175], 0
    v_exp_f32 v82, v98
    v_exp_f32 v83, v99
    v_mfma_f32_16x16x32_bf16 v[116:119], v[60:63], v[168:171], 0
    v_exp_f32 v84, v100
    v_exp_f32 v85, v101
    v_mfma_f32_16x16x32_bf16 v[124:127], v[60:63], v[172:175], 0
    v_exp_f32 v86, v102
    v_exp_f32 v87, v103
    v_mfma_f32_16x16x32_bf16 v[112:115], v[64:67], v[200:203], v[112:115]
    v_lshlrev_b32_sdwa v104, 1, v104 dst_sel:DWORD dst_unused:UNUSED_PAD src0_sel:DWORD src1_sel:WORD_1
    v_lshlrev_b32_sdwa v105, 1, v105 dst_sel:DWORD dst_unused:UNUSED_PAD src0_sel:DWORD src1_sel:WORD_1
    ds_read_u16_d16_hi v88, v104
    ds_read_u16_d16_hi v89, v105
    v_mfma_f32_16x16x32_bf16 v[120:123], v[64:67], v[204:207], v[120:123]
    v_lshlrev_b32_sdwa v106, 1, v106 dst_sel:DWORD dst_unused:UNUSED_PAD src0_sel:DWORD src1_sel:WORD_1
    v_lshlrev_b32_sdwa v107, 1, v107 dst_sel:DWORD dst_unused:UNUSED_PAD src0_sel:DWORD src1_sel:WORD_1
    ds_read_u16_d16_hi v90, v106
    ds_read_u16_d16_hi v91, v107
    v_mfma_f32_16x16x32_bf16 v[116:119], v[68:71], v[200:203], v[116:119]
    v_lshlrev_b32_sdwa v108, 1, v108 dst_sel:DWORD dst_unused:UNUSED_PAD src0_sel:DWORD src1_sel:WORD_1
    v_lshlrev_b32_sdwa v109, 1, v109 dst_sel:DWORD dst_unused:UNUSED_PAD src0_sel:DWORD src1_sel:WORD_1
    ds_read_u16_d16_hi v92, v108
    ds_read_u16_d16_hi v93, v109
    v_mfma_f32_16x16x32_bf16 v[124:127], v[68:71], v[204:207], v[124:127]
    v_lshlrev_b32_sdwa v110, 1, v110 dst_sel:DWORD dst_unused:UNUSED_PAD src0_sel:DWORD src1_sel:WORD_1
    v_lshlrev_b32_sdwa v111, 1, v111 dst_sel:DWORD dst_unused:UNUSED_PAD src0_sel:DWORD src1_sel:WORD_1
    ds_read_u16_d16_hi v94, v110
    ds_read_u16_d16_hi v95, v111
    v_add_f32 v80, 1.0, v80
    v_add_f32 v81, 1.0, v81
    ds_read_u16 v12, v9 offset:64
    v_add_f32 v82, 1.0, v82
    v_add_f32 v83, 1.0, v83
    ds_read_u16 v13, v9 offset:68
    v_add_f32 v84, 1.0, v84
    v_add_f32 v85, 1.0, v85
    v_add_f32 v86, 1.0, v86
    v_add_f32 v87, 1.0, v87
    v_mfma_f32_16x16x32_bf16 v[112:115], v[48:51], v[232:235], v[112:115]
    v_rcp_f32 v80, v80
    v_mfma_f32_16x16x32_bf16 v[120:123], v[48:51], v[236:239], v[120:123]
    v_rcp_f32 v81, v81
    v_mfma_f32_16x16x32_bf16 v[116:119], v[52:55], v[232:235], v[116:119]
    v_rcp_f32 v82, v82
    v_mfma_f32_16x16x32_bf16 v[124:127], v[52:55], v[236:239], v[124:127]
    v_rcp_f32 v83, v83
    v_rcp_f32 v84, v84
    v_mfma_f32_16x16x32_bf16 v[72:75], v[48:51], v[48:51], 0
    v_rcp_f32 v85, v85
    v_rcp_f32 v86, v86
    v_rcp_f32 v87, v87
    v_mfma_f32_16x16x32_bf16 v[72:75], v[52:55], v[52:55], v[72:75]
    v_mul_f32 v80, v80, v96
    v_mul_f32 v81, v81, v97
    v_mul_f32 v82, v82, v98
    v_mul_f32 v83, v83, v99
    v_mul_f32 v84, v84, v100
    v_mul_f32 v85, v85, v101
    v_mul_f32 v86, v86, v102
    v_mul_f32 v87, v87, v103
    s_waitcnt lgkmcnt(0)
    v_mfma_f32_16x16x32_bf16 v[96:99], v[56:59], v[176:179], 0
    v_lshlrev_b32_sdwa v112, 1, v112 dst_sel:DWORD dst_unused:UNUSED_PAD src0_sel:DWORD src1_sel:WORD_1
    v_lshlrev_b32_sdwa v113, 1, v113 dst_sel:DWORD dst_unused:UNUSED_PAD src0_sel:DWORD src1_sel:WORD_1
    ds_read_u16_d16_hi v32, v112
    v_mfma_f32_16x16x32_bf16 v[104:107], v[56:59], v[180:183], 0
    v_xad_u32 v12, v12, v29, v5
    ds_read_u16_d16_hi v33, v113
    v_xad_u32 v13, v13, v29, v5
    v_mfma_f32_16x16x32_bf16 v[100:103], v[60:63], v[176:179], 0
    v_lshlrev_b32_sdwa v114, 1, v114 dst_sel:DWORD dst_unused:UNUSED_PAD src0_sel:DWORD src1_sel:WORD_1
    v_lshlrev_b32_sdwa v115, 1, v115 dst_sel:DWORD dst_unused:UNUSED_PAD src0_sel:DWORD src1_sel:WORD_1
    ds_read_u16_d16_hi v34, v114
    v_mfma_f32_16x16x32_bf16 v[108:111], v[60:63], v[180:183], 0
    ds_read_u16_d16_hi v35, v115
    v_lshlrev_b32_sdwa v116, 1, v116 dst_sel:DWORD dst_unused:UNUSED_PAD src0_sel:DWORD src1_sel:WORD_1
    v_lshlrev_b32_sdwa v117, 1, v117 dst_sel:DWORD dst_unused:UNUSED_PAD src0_sel:DWORD src1_sel:WORD_1
    v_mfma_f32_16x16x32_bf16 v[96:99], v[64:67], v[208:211], v[96:99]
    ds_read_u16_d16_hi v36, v116
    ds_read_u16_d16_hi v37, v117
    v_lshlrev_b32_sdwa v118, 1, v118 dst_sel:DWORD dst_unused:UNUSED_PAD src0_sel:DWORD src1_sel:WORD_1
    v_mfma_f32_16x16x32_bf16 v[104:107], v[64:67], v[212:215], v[104:107]
    v_lshlrev_b32_sdwa v119, 1, v119 dst_sel:DWORD dst_unused:UNUSED_PAD src0_sel:DWORD src1_sel:WORD_1
    ds_read_u16_d16_hi v38, v118
M_H9:
    s_cbranch_execz A_RET
    s_add_u32 m0, s43, 0
    v_mfma_f32_16x16x32_bf16 v[100:103], v[68:71], v[208:211], v[100:103]
    ds_read_u16_d16_hi v39, v119
    buffer_load_dwordx4 v16, s[12:15], 0 offen lds
    v_lshlrev_b32_sdwa v120, 1, v120 dst_sel:DWORD dst_unused:UNUSED_PAD src0_sel:DWORD src1_sel:WORD_1
    v_lshlrev_b32_sdwa v121, 1, v121 dst_sel:DWORD dst_unused:UNUSED_PAD src0_sel:DWORD src1_sel:WORD_1
    v_mfma_f32_16x16x32_bf16 v[108:111], v[68:71], v[212:215], v[108:111]
    ds_read_u16_d16_hi v40, v120
    s_add_u32 m0, s43, 1024
    ds_read_u16_d16_hi v41, v121
    v_mfma_f32_16x16x32_bf16 v[96:99], v[48:51], v[240:243], v[96:99]
    buffer_load_dwordx4 v17, s[12:15], 0 offen lds
    v_lshlrev_b32_sdwa v122, 1, v122 dst_sel:DWORD dst_unused:UNUSED_PAD src0_sel:DWORD src1_sel:WORD_1
    v_lshlrev_b32_sdwa v123, 1, v123 dst_sel:DWORD dst_unused:UNUSED_PAD src0_sel:DWORD src1_sel:WORD_1
    v_mfma_f32_16x16x32_bf16 v[104:107], v[48:51], v[244:247], v[104:107]
    ds_read_u16_d16_hi v42, v122
    s_add_u32 m0, s43, 2048
    ds_read_u16_d16_hi v43, v123
    v_mfma_f32_16x16x32_bf16 v[100:103], v[52:55], v[240:243], v[100:103]
    buffer_load_dwordx4 v18, s[12:15], 0 offen lds
    v_lshlrev_b32_sdwa v124, 1, v124 dst_sel:DWORD dst_unused:UNUSED_PAD src0_sel:DWORD src1_sel:WORD_1
    v_lshlrev_b32_sdwa v125, 1, v125 dst_sel:DWORD dst_unused:UNUSED_PAD src0_sel:DWORD src1_sel:WORD_1
    v_mfma_f32_16x16x32_bf16 v[108:111], v[52:55], v[244:247], v[108:111]
    ds_read_u16_d16_hi v44, v124
    s_add_u32 m0, s43, 3072
    ds_read_u16_d16_hi v45, v125
    v_smfmac_f32_16x16x64_bf16 v[128:131], v[20:23], v[80:87], v10 abid:1
    buffer_load_dwordx4 v19, s[12:15], 0 offen lds
    v_lshlrev_b32_sdwa v126, 1, v126 dst_sel:DWORD dst_unused:UNUSED_PAD src0_sel:DWORD src1_sel:WORD_1
    v_lshlrev_b32_sdwa v127, 1, v127 dst_sel:DWORD dst_unused:UNUSED_PAD src0_sel:DWORD src1_sel:WORD_1
    v_smfmac_f32_16x16x64_bf16 v[132:135], v[20:23], v[88:95], v10 abid:1
    ds_read_u16_d16_hi v46, v126
    s_add_u32 m0, s43, 4096
    ds_read_u16_d16_hi v47, v127
    buffer_load_dwordx4 v11, s[16:19], 0 offen lds
    s_branch M_MID
M_LOOP0:
    s_waitcnt lgkmcnt(0)
    v_mfma_f32_16x16x32_bf16 v[96:99], v[56:59], v[160:163], 0
    v_lshlrev_b32_sdwa v112, 1, v112 dst_sel:DWORD dst_unused:UNUSED_PAD src0_sel:DWORD src1_sel:WORD_1
    v_lshlrev_b32_sdwa v113, 1, v113 dst_sel:DWORD dst_unused:UNUSED_PAD src0_sel:DWORD src1_sel:WORD_1
    ds_read_u16_d16_hi v32, v112
    v_mfma_f32_16x16x32_bf16 v[104:107], v[56:59], v[164:167], 0
    v_add_u32 v16, v16, v2
    ds_read_u16_d16_hi v33, v113
    v_xad_u32 v17, v2, 64, v17
    v_lshlrev_b32_sdwa v114, 1, v114 dst_sel:DWORD dst_unused:UNUSED_PAD src0_sel:DWORD src1_sel:WORD_1
    v_mfma_f32_16x16x32_bf16 v[100:103], v[60:63], v[160:163], 0
    v_lshlrev_b32_sdwa v115, 1, v115 dst_sel:DWORD dst_unused:UNUSED_PAD src0_sel:DWORD src1_sel:WORD_1
    ds_read_u16_d16_hi v34, v114
    v_add_u32 v18, v18, v2
    ds_read_u16_d16_hi v35, v115
    v_mfma_f32_16x16x32_bf16 v[108:111], v[60:63], v[164:167], 0
    v_xad_u32 v19, v2, 64, v19
    v_lshlrev_b32_sdwa v116, 1, v116 dst_sel:DWORD dst_unused:UNUSED_PAD src0_sel:DWORD src1_sel:WORD_1
    v_lshlrev_b32_sdwa v117, 1, v117 dst_sel:DWORD dst_unused:UNUSED_PAD src0_sel:DWORD src1_sel:WORD_1
    ds_read_u16_d16_hi v36, v116
    v_mfma_f32_16x16x32_bf16 v[96:99], v[64:67], v[192:195], v[96:99]
    v_add_u32 v11, v11, v3
    ds_read_u16_d16_hi v37, v117
    v_xor_b32_sdwa v15, v4, v14 dst_sel:DWORD dst_unused:UNUSED_PAD src0_sel:DWORD src1_sel:WORD_1
    v_mfma_f32_16x16x32_bf16 v[104:107], v[64:67], v[196:199], v[104:107]
    v_lshlrev_b32_sdwa v118, 1, v118 dst_sel:DWORD dst_unused:UNUSED_PAD src0_sel:DWORD src1_sel:WORD_1
    v_lshlrev_b32_sdwa v119, 1, v119 dst_sel:DWORD dst_unused:UNUSED_PAD src0_sel:DWORD src1_sel:WORD_1
    ds_read_u16_d16_hi v38, v118
    s_add_u32 m0, s43, 0
    v_mfma_f32_16x16x32_bf16 v[100:103], v[68:71], v[192:195], v[100:103]
    v_xor_b32_sdwa v14, v4, v14 dst_sel:DWORD dst_unused:UNUSED_PAD src0_sel:DWORD src1_sel:WORD_0
    ds_read_u16_d16_hi v39, v119
    v_add_u32 v6, 256, v6
    buffer_load_dwordx4 v16, s[12:15], 0 offen lds
    v_mfma_f32_16x16x32_bf16 v[108:111], v[68:71], v[196:199], v[108:111]
    v_lshlrev_b32_sdwa v120, 1, v120 dst_sel:DWORD dst_unused:UNUSED_PAD src0_sel:DWORD src1_sel:WORD_1
    v_lshlrev_b32_sdwa v121, 1, v121 dst_sel:DWORD dst_unused:UNUSED_PAD src0_sel:DWORD src1_sel:WORD_1
    ds_read_u16_d16_hi v40, v120
    s_add_u32 m0, s43, 1024
    v_mfma_f32_16x16x32_bf16 v[96:99], v[48:51], v[224:227], v[96:99]
    v_add_u32 v7, 256, v7
    ds_read_u16_d16_hi v41, v121
    v_add_u32 v8, 128, v8
    buffer_load_dwordx4 v17, s[12:15], 0 offen lds
    v_mfma_f32_16x16x32_bf16 v[104:107], v[48:51], v[228:231], v[104:107]
    v_lshlrev_b32_sdwa v122, 1, v122 dst_sel:DWORD dst_unused:UNUSED_PAD src0_sel:DWORD src1_sel:WORD_1
    v_lshlrev_b32_sdwa v123, 1, v123 dst_sel:DWORD dst_unused:UNUSED_PAD src0_sel:DWORD src1_sel:WORD_1
    ds_read_u16_d16_hi v42, v122
    v_mfma_f32_16x16x32_bf16 v[100:103], v[52:55], v[224:227], v[100:103]
    s_add_u32 m0, s43, 2048
    v_lshl_add_u32 v9, v3, 3, v9
    ds_read_u16_d16_hi v43, v123
    buffer_load_dwordx4 v18, s[12:15], 0 offen lds
    v_mfma_f32_16x16x32_bf16 v[108:111], v[52:55], v[228:231], v[108:111]
    v_lshlrev_b32_sdwa v124, 1, v124 dst_sel:DWORD dst_unused:UNUSED_PAD src0_sel:DWORD src1_sel:WORD_1
    v_lshlrev_b32_sdwa v125, 1, v125 dst_sel:DWORD dst_unused:UNUSED_PAD src0_sel:DWORD src1_sel:WORD_1
    ds_read_u16_d16_hi v44, v124
    s_add_u32 m0, s43, 3072
    v_smfmac_f32_16x16x64_bf16 v[144:147], v[20:23], v[80:87], v10 abid:1
    ds_read_u16_d16_hi v45, v125
    buffer_load_dwordx4 v19, s[12:15], 0 offen lds
    v_lshlrev_b32_sdwa v126, 1, v126 dst_sel:DWORD dst_unused:UNUSED_PAD src0_sel:DWORD src1_sel:WORD_1
    v_lshlrev_b32_sdwa v127, 1, v127 dst_sel:DWORD dst_unused:UNUSED_PAD src0_sel:DWORD src1_sel:WORD_1
    v_smfmac_f32_16x16x64_bf16 v[148:151], v[20:23], v[88:95], v10 abid:1
    ds_read_u16_d16_hi v46, v126
    s_add_u32 m0, s43, 4096
    ds_read_u16_d16_hi v47, v127
    buffer_load_dwordx4 v11, s[16:19], 0 offen lds
M_LOOP:
    v_mfma_f32_16x16x32_bf16 v[112:115], v[56:59], v[168:171], 0
    v_exp_f32 v80, v96
    v_exp_f32 v81, v97
    v_mfma_f32_16x16x32_bf16 v[120:123], v[56:59], v[172:175], 0
    v_exp_f32 v82, v98
    v_exp_f32 v83, v99
    v_mfma_f32_16x16x32_bf16 v[116:119], v[60:63], v[168:171], 0
    v_exp_f32 v84, v100
    ds_read_u16 v12, v9 offset:64
    v_exp_f32 v85, v101
    ds_read_u16 v13, v9 offset:68
    v_mfma_f32_16x16x32_bf16 v[124:127], v[60:63], v[172:175], 0
    v_exp_f32 v86, v102
    v_exp_f32 v87, v103
    v_mfma_f32_16x16x32_bf16 v[112:115], v[64:67], v[200:203], v[112:115]
    v_lshlrev_b32_sdwa v104, 1, v104 dst_sel:DWORD dst_unused:UNUSED_PAD src0_sel:DWORD src1_sel:WORD_1
    v_lshlrev_b32_sdwa v105, 1, v105 dst_sel:DWORD dst_unused:UNUSED_PAD src0_sel:DWORD src1_sel:WORD_1
    ds_read_u16_d16_hi v88, v104
    ds_read_u16_d16_hi v89, v105
    v_mfma_f32_16x16x32_bf16 v[120:123], v[64:67], v[204:207], v[120:123]
    v_lshlrev_b32_sdwa v106, 1, v106 dst_sel:DWORD dst_unused:UNUSED_PAD src0_sel:DWORD src1_sel:WORD_1
    v_lshlrev_b32_sdwa v107, 1, v107 dst_sel:DWORD dst_unused:UNUSED_PAD src0_sel:DWORD src1_sel:WORD_1
    ds_read_u16_d16_hi v90, v106
    ds_read_u16_d16_hi v91, v107
    v_mfma_f32_16x16x32_bf16 v[116:119], v[68:71], v[200:203], v[116:119]
    v_lshlrev_b32_sdwa v108, 1, v108 dst_sel:DWORD dst_unused:UNUSED_PAD src0_sel:DWORD src1_sel:WORD_1
    v_lshlrev_b32_sdwa v109, 1, v109 dst_sel:DWORD dst_unused:UNUSED_PAD src0_sel:DWORD src1_sel:WORD_1
    ds_read_u16_d16_hi v92, v108
    ds_read_u16_d16_hi v93, v109
    v_mfma_f32_16x16x32_bf16 v[124:127], v[68:71], v[204:207], v[124:127]
    v_lshlrev_b32_sdwa v110, 1, v110 dst_sel:DWORD dst_unused:UNUSED_PAD src0_sel:DWORD src1_sel:WORD_1
M_H10:
    s_cbranch_execz A_RET
    v_lshlrev_b32_sdwa v111, 1, v111 dst_sel:DWORD dst_unused:UNUSED_PAD src0_sel:DWORD src1_sel:WORD_1
    ds_read_u16_d16_hi v94, v110
    ds_read_u16_d16_hi v95, v111
    s_setprio 0
    v_add_f32 v80, 1.0, v80
    v_add_f32 v81, 1.0, v81
    v_add_f32 v82, 1.0, v82
    v_add_f32 v83, 1.0, v83
    v_add_f32 v84, 1.0, v84
    v_add_f32 v85, 1.0, v85
    v_add_f32 v86, 1.0, v86
    v_add_f32 v87, 1.0, v87
    s_setprio 1
    v_mfma_f32_16x16x32_bf16 v[112:115], v[48:51], v[232:235], v[112:115]
    v_rcp_f32 v80, v80
    v_mfma_f32_16x16x32_bf16 v[120:123], v[48:51], v[236:239], v[120:123]
    v_rcp_f32 v81, v81
    v_mfma_f32_16x16x32_bf16 v[116:119], v[52:55], v[232:235], v[116:119]
    v_rcp_f32 v82, v82
    v_mfma_f32_16x16x32_bf16 v[124:127], v[52:55], v[236:239], v[124:127]
    v_rcp_f32 v83, v83
    s_waitcnt lgkmcnt(8)
    v_smfmac_f32_16x16x64_bf16 v[152:155], v[20:23], v[32:39], v10 abid:1
    v_rcp_f32 v84, v84
    v_mfma_f32_16x16x32_bf16 v[72:75], v[48:51], v[48:51], v[72:75]
    v_rcp_f32 v85, v85
    v_smfmac_f32_16x16x64_bf16 v[156:159], v[20:23], v[40:47], v10 abid:1
    v_rcp_f32 v86, v86
    ds_read_b64_tr_b16 v[20:21], v14
    ds_read_b64_tr_b16 v[22:23], v15
    v_rcp_f32 v87, v87
    v_mfma_f32_16x16x32_bf16 v[72:75], v[52:55], v[52:55], v[72:75]
    s_setprio 0
    v_mul_f32 v80, v80, v96
    v_mul_f32 v81, v81, v97
    v_mul_f32 v82, v82, v98
    v_mul_f32 v83, v83, v99
    v_mul_f32 v84, v84, v100
    v_mul_f32 v85, v85, v101
    v_mul_f32 v86, v86, v102
    v_mul_f32 v87, v87, v103
    s_setprio 1
    s_cbranch_vccz M_U1
    s_setprio 2
M_U1:
    v_mfma_f32_16x16x32_bf16 v[96:99], v[56:59], v[176:179], 0
    v_lshlrev_b32_sdwa v112, 1, v112 dst_sel:DWORD dst_unused:UNUSED_PAD src0_sel:DWORD src1_sel:WORD_1
    v_lshlrev_b32_sdwa v113, 1, v113 dst_sel:DWORD dst_unused:UNUSED_PAD src0_sel:DWORD src1_sel:WORD_1
    v_mfma_f32_16x16x32_bf16 v[104:107], v[56:59], v[180:183], 0
    ds_read_u16_d16_hi v32, v112
    v_xad_u32 v12, v12, v29, v5
    v_mfma_f32_16x16x32_bf16 v[100:103], v[60:63], v[176:179], 0
    ds_read_u16_d16_hi v33, v113
    v_xad_u32 v13, v13, v29, v5
    v_lshlrev_b32_sdwa v114, 1, v114 dst_sel:DWORD dst_unused:UNUSED_PAD src0_sel:DWORD src1_sel:WORD_1
    v_mfma_f32_16x16x32_bf16 v[108:111], v[60:63], v[180:183], 0
    v_lshlrev_b32_sdwa v115, 1, v115 dst_sel:DWORD dst_unused:UNUSED_PAD src0_sel:DWORD src1_sel:WORD_1
    ds_read_u16_d16_hi v34, v114
    v_mfma_f32_16x16x32_bf16 v[96:99], v[64:67], v[208:211], v[96:99]
    ds_read_u16_d16_hi v35, v115
    v_lshlrev_b32_sdwa v116, 1, v116 dst_sel:DWORD dst_unused:UNUSED_PAD src0_sel:DWORD src1_sel:WORD_1
    v_lshlrev_b32_sdwa v117, 1, v117 dst_sel:DWORD dst_unused:UNUSED_PAD src0_sel:DWORD src1_sel:WORD_1
    v_mfma_f32_16x16x32_bf16 v[104:107], v[64:67], v[212:215], v[104:107]
    ds_read_u16_d16_hi v36, v116
    ds_read_u16_d16_hi v37, v117
    v_mfma_f32_16x16x32_bf16 v[100:103], v[68:71], v[208:211], v[100:103]
    v_lshlrev_b32_sdwa v118, 1, v118 dst_sel:DWORD dst_unused:UNUSED_PAD src0_sel:DWORD src1_sel:WORD_1
    v_lshlrev_b32_sdwa v119, 1, v119 dst_sel:DWORD dst_unused:UNUSED_PAD src0_sel:DWORD src1_sel:WORD_1
    ds_read_u16_d16_hi v38, v118
    v_mfma_f32_16x16x32_bf16 v[108:111], v[68:71], v[212:215], v[108:111]
    ds_read_u16_d16_hi v39, v119
    v_lshlrev_b32_sdwa v120, 1, v120 dst_sel:DWORD dst_unused:UNUSED_PAD src0_sel:DWORD src1_sel:WORD_1
    v_mfma_f32_16x16x32_bf16 v[96:99], v[48:51], v[240:243], v[96:99]
    v_lshlrev_b32_sdwa v121, 1, v121 dst_sel:DWORD dst_unused:UNUSED_PAD src0_sel:DWORD src1_sel:WORD_1
    ds_read_u16_d16_hi v40, v120
    v_mfma_f32_16x16x32_bf16 v[104:107], v[48:51], v[244:247], v[104:107]
    ds_read_u16_d16_hi v41, v121
    v_lshlrev_b32_sdwa v122, 1, v122 dst_sel:DWORD dst_unused:UNUSED_PAD src0_sel:DWORD src1_sel:WORD_1
    v_lshlrev_b32_sdwa v123, 1, v123 dst_sel:DWORD dst_unused:UNUSED_PAD src0_sel:DWORD src1_sel:WORD_1
    v_mfma_f32_16x16x32_bf16 v[100:103], v[52:55], v[240:243], v[100:103]
    ds_read_u16_d16_hi v42, v122
    ds_read_u16_d16_hi v43, v123
    v_mfma_f32_16x16x32_bf16 v[108:111], v[52:55], v[244:247], v[108:111]
    v_lshlrev_b32_sdwa v124, 1, v124 dst_sel:DWORD dst_unused:UNUSED_PAD src0_sel:DWORD src1_sel:WORD_1
    v_lshlrev_b32_sdwa v125, 1, v125 dst_sel:DWORD dst_unused:UNUSED_PAD src0_sel:DWORD src1_sel:WORD_1
    ds_read_u16_d16_hi v44, v124
    s_waitcnt lgkmcnt(13)
    v_smfmac_f32_16x16x64_bf16 v[128:131], v[20:23], v[80:87], v10 abid:1
    ds_read_u16_d16_hi v45, v125
    v_lshlrev_b32_sdwa v126, 1, v126 dst_sel:DWORD dst_unused:UNUSED_PAD src0_sel:DWORD src1_sel:WORD_1
    v_smfmac_f32_16x16x64_bf16 v[132:135], v[20:23], v[88:95], v10 abid:1
    v_lshlrev_b32_sdwa v127, 1, v127 dst_sel:DWORD dst_unused:UNUSED_PAD src0_sel:DWORD src1_sel:WORD_1
    ds_read_u16_d16_hi v46, v126
    ds_read_u16_d16_hi v47, v127
M_MID:
    s_waitcnt vmcnt(5)
    v_mfma_f32_16x16x32_bf16 v[112:115], v[56:59], v[184:187], 0
    v_exp_f32 v80, v96
    ds_read_b128 v[16:19], v6 offset:384
    v_exp_f32 v81, v97
    v_mfma_f32_16x16x32_bf16 v[120:123], v[56:59], v[188:191], 0
    v_exp_f32 v82, v98
    ds_read_b128 v[56:59], v0 offset:40960
    v_exp_f32 v83, v99
    v_mfma_f32_16x16x32_bf16 v[116:119], v[60:63], v[184:187], 0
    v_exp_f32 v84, v100
    ds_read_b32 v11, v7 offset:384
    v_exp_f32 v85, v101
    v_mfma_f32_16x16x32_bf16 v[124:127], v[60:63], v[188:191], 0
    v_exp_f32 v86, v102
    ds_read_b128 v[60:63], v0 offset:43008
    v_exp_f32 v87, v103
    v_mfma_f32_16x16x32_bf16 v[112:115], v[64:67], v[216:219], v[112:115]
    v_lshlrev_b32_sdwa v104, 1, v104 dst_sel:DWORD dst_unused:UNUSED_PAD src0_sel:DWORD src1_sel:WORD_1
    v_lshlrev_b32_sdwa v105, 1, v105 dst_sel:DWORD dst_unused:UNUSED_PAD src0_sel:DWORD src1_sel:WORD_1
    ds_read_b32 v14, v8 offset:64
    v_or3_b32 v10, v104, v105, v10
    ds_read_u16_d16_hi v88, v104
    ds_read_u16_d16_hi v89, v105
    v_mfma_f32_16x16x32_bf16 v[120:123], v[64:67], v[220:223], v[120:123]
    v_lshlrev_b32_sdwa v106, 1, v106 dst_sel:DWORD dst_unused:UNUSED_PAD src0_sel:DWORD src1_sel:WORD_1
    v_lshlrev_b32_sdwa v107, 1, v107 dst_sel:DWORD dst_unused:UNUSED_PAD src0_sel:DWORD src1_sel:WORD_1
    ds_read_b128 v[64:67], v1 offset:40960
    ds_read_u16_d16_hi v90, v106
    ds_read_u16_d16_hi v91, v107
    v_mfma_f32_16x16x32_bf16 v[116:119], v[68:71], v[216:219], v[116:119]
    v_lshlrev_b32_sdwa v108, 1, v108 dst_sel:DWORD dst_unused:UNUSED_PAD src0_sel:DWORD src1_sel:WORD_1
    v_lshlrev_b32_sdwa v109, 1, v109 dst_sel:DWORD dst_unused:UNUSED_PAD src0_sel:DWORD src1_sel:WORD_1
    ds_read_u16_d16_hi v92, v108
    ds_read_u16_d16_hi v93, v109
    v_mfma_f32_16x16x32_bf16 v[124:127], v[68:71], v[220:223], v[124:127]
    v_lshlrev_b32_sdwa v110, 1, v110 dst_sel:DWORD dst_unused:UNUSED_PAD src0_sel:DWORD src1_sel:WORD_1
    v_lshlrev_b32_sdwa v111, 1, v111 dst_sel:DWORD dst_unused:UNUSED_PAD src0_sel:DWORD src1_sel:WORD_1
    ds_read_b128 v[68:71], v1 offset:43008
    ds_read_u16_d16_hi v94, v110
    ds_read_u16_d16_hi v95, v111
    s_setprio 0
    v_add_f32 v80, 1.0, v80
    v_add_f32 v81, 1.0, v81
    v_add_f32 v82, 1.0, v82
    v_add_f32 v83, 1.0, v83
    v_add_f32 v84, 1.0, v84
    v_add_f32 v85, 1.0, v85
    v_add_f32 v86, 1.0, v86
    v_add_f32 v87, 1.0, v87
    s_setprio 1
    v_mfma_f32_16x16x32_bf16 v[112:115], v[48:51], v[248:251], v[112:115]
    v_rcp_f32 v80, v80
    v_mfma_f32_16x16x32_bf16 v[120:123], v[48:51], v[252:255], v[120:123]
    v_rcp_f32 v81, v81
    ds_read_b128 v[48:51], v12
    v_mfma_f32_16x16x32_bf16 v[116:119], v[52:55], v[248:251], v[116:119]
    v_rcp_f32 v82, v82
    v_mfma_f32_16x16x32_bf16 v[124:127], v[52:55], v[252:255], v[124:127]
    v_rcp_f32 v83, v83
    ds_read_b128 v[52:55], v13
    s_waitcnt lgkmcnt(15)
    v_smfmac_f32_16x16x64_bf16 v[136:139], v[20:23], v[32:39], v10 abid:1
M_H11:
    s_cbranch_execz A_RET
    v_rcp_f32 v84, v84
    v_rcp_f32 v85, v85
    v_smfmac_f32_16x16x64_bf16 v[140:143], v[20:23], v[40:47], v10 abid:1
    v_rcp_f32 v86, v86
    v_rcp_f32 v87, v87
    s_setprio 0
    v_mul_f32 v80, v80, v96
    v_mul_f32 v81, v81, v97
    v_mul_f32 v82, v82, v98
    v_mul_f32 v83, v83, v99
    v_mul_f32 v84, v84, v100
    v_mul_f32 v85, v85, v101
    v_mul_f32 v86, v86, v102
    v_mul_f32 v87, v87, v103
    s_setprio 1
    s_sub_u32 s42, s42, 1
    s_cmp_le_u32 s42, s62
    s_cbranch_scc1 M_LX
    s_waitcnt lgkmcnt(0)
    v_mfma_f32_16x16x32_bf16 v[96:99], v[56:59], v[160:163], 0
    v_lshlrev_b32_sdwa v112, 1, v112 dst_sel:DWORD dst_unused:UNUSED_PAD src0_sel:DWORD src1_sel:WORD_1
    v_lshlrev_b32_sdwa v113, 1, v113 dst_sel:DWORD dst_unused:UNUSED_PAD src0_sel:DWORD src1_sel:WORD_1
    ds_read_u16_d16_hi v32, v112
    v_mfma_f32_16x16x32_bf16 v[104:107], v[56:59], v[164:167], 0
    v_add_u32 v16, v16, v2
    ds_read_u16_d16_hi v33, v113
    v_xad_u32 v17, v2, 64, v17
    v_lshlrev_b32_sdwa v114, 1, v114 dst_sel:DWORD dst_unused:UNUSED_PAD src0_sel:DWORD src1_sel:WORD_1
    v_mfma_f32_16x16x32_bf16 v[100:103], v[60:63], v[160:163], 0
    v_lshlrev_b32_sdwa v115, 1, v115 dst_sel:DWORD dst_unused:UNUSED_PAD src0_sel:DWORD src1_sel:WORD_1
    ds_read_u16_d16_hi v34, v114
    v_add_u32 v18, v18, v2
    v_mfma_f32_16x16x32_bf16 v[108:111], v[60:63], v[164:167], 0
    ds_read_u16_d16_hi v35, v115
    v_xad_u32 v19, v2, 64, v19
    v_lshlrev_b32_sdwa v116, 1, v116 dst_sel:DWORD dst_unused:UNUSED_PAD src0_sel:DWORD src1_sel:WORD_1
    v_lshlrev_b32_sdwa v117, 1, v117 dst_sel:DWORD dst_unused:UNUSED_PAD src0_sel:DWORD src1_sel:WORD_1
    v_mfma_f32_16x16x32_bf16 v[96:99], v[64:67], v[192:195], v[96:99]
    ds_read_u16_d16_hi v36, v116
    v_add_u32 v11, v11, v3
    ds_read_u16_d16_hi v37, v117
    v_mfma_f32_16x16x32_bf16 v[104:107], v[64:67], v[196:199], v[104:107]
    v_xor_b32_sdwa v15, v4, v14 dst_sel:DWORD dst_unused:UNUSED_PAD src0_sel:DWORD src1_sel:WORD_1
    v_lshlrev_b32_sdwa v118, 1, v118 dst_sel:DWORD dst_unused:UNUSED_PAD src0_sel:DWORD src1_sel:WORD_1
    v_lshlrev_b32_sdwa v119, 1, v119 dst_sel:DWORD dst_unused:UNUSED_PAD src0_sel:DWORD src1_sel:WORD_1
    ds_read_u16_d16_hi v38, v118
    v_mfma_f32_16x16x32_bf16 v[100:103], v[68:71], v[192:195], v[100:103]
    s_add_u32 m0, s43, 40960
    v_xor_b32_sdwa v14, v4, v14 dst_sel:DWORD dst_unused:UNUSED_PAD src0_sel:DWORD src1_sel:WORD_0
    ds_read_u16_d16_hi v39, v119
    v_mfma_f32_16x16x32_bf16 v[108:111], v[68:71], v[196:199], v[108:111]
    buffer_load_dwordx4 v16, s[12:15], 0 offen lds
    v_lshlrev_b32_sdwa v120, 1, v120 dst_sel:DWORD dst_unused:UNUSED_PAD src0_sel:DWORD src1_sel:WORD_1
    v_lshlrev_b32_sdwa v121, 1, v121 dst_sel:DWORD dst_unused:UNUSED_PAD src0_sel:DWORD src1_sel:WORD_1
    ds_read_u16_d16_hi v40, v120
    v_mfma_f32_16x16x32_bf16 v[96:99], v[48:51], v[224:227], v[96:99]
    s_add_u32 m0, s43, 41984
    ds_read_u16_d16_hi v41, v121
    buffer_load_dwordx4 v17, s[12:15], 0 offen lds
    v_mfma_f32_16x16x32_bf16 v[104:107], v[48:51], v[228:231], v[104:107]
    v_lshlrev_b32_sdwa v122, 1, v122 dst_sel:DWORD dst_unused:UNUSED_PAD src0_sel:DWORD src1_sel:WORD_1
    v_lshlrev_b32_sdwa v123, 1, v123 dst_sel:DWORD dst_unused:UNUSED_PAD src0_sel:DWORD src1_sel:WORD_1
    ds_read_u16_d16_hi v42, v122
    s_add_u32 m0, s43, 43008
    v_mfma_f32_16x16x32_bf16 v[100:103], v[52:55], v[224:227], v[100:103]
    ds_read_u16_d16_hi v43, v123
    buffer_load_dwordx4 v18, s[12:15], 0 offen lds
    v_lshlrev_b32_sdwa v124, 1, v124 dst_sel:DWORD dst_unused:UNUSED_PAD src0_sel:DWORD src1_sel:WORD_1
    v_mfma_f32_16x16x32_bf16 v[108:111], v[52:55], v[228:231], v[108:111]
    v_lshlrev_b32_sdwa v125, 1, v125 dst_sel:DWORD dst_unused:UNUSED_PAD src0_sel:DWORD src1_sel:WORD_1
    ds_read_u16_d16_hi v44, v124
    s_add_u32 m0, s43, 44032
    ds_read_u16_d16_hi v45, v125
    v_smfmac_f32_16x16x64_bf16 v[144:147], v[20:23], v[80:87], v10 abid:1
    buffer_load_dwordx4 v19, s[12:15], 0 offen lds
    v_lshlrev_b32_sdwa v126, 1, v126 dst_sel:DWORD dst_unused:UNUSED_PAD src0_sel:DWORD src1_sel:WORD_1
    v_lshlrev_b32_sdwa v127, 1, v127 dst_sel:DWORD dst_unused:UNUSED_PAD src0_sel:DWORD src1_sel:WORD_1
    v_smfmac_f32_16x16x64_bf16 v[148:151], v[20:23], v[88:95], v10 abid:1
    ds_read_u16_d16_hi v46, v126
    s_add_u32 m0, s43, 45056
    ds_read_u16_d16_hi v47, v127
    buffer_load_dwordx4 v11, s[16:19], 0 offen lds
    v_mfma_f32_16x16x32_bf16 v[112:115], v[56:59], v[168:171], 0
    v_exp_f32 v80, v96
    v_exp_f32 v81, v97
    v_mfma_f32_16x16x32_bf16 v[120:123], v[56:59], v[172:175], 0
    v_exp_f32 v82, v98
    v_exp_f32 v83, v99
    v_mfma_f32_16x16x32_bf16 v[116:119], v[60:63], v[168:171], 0
    v_exp_f32 v84, v100
    ds_read_u16 v12, v9 offset:128
    v_exp_f32 v85, v101
    ds_read_u16 v13, v9 offset:132
    v_mfma_f32_16x16x32_bf16 v[124:127], v[60:63], v[172:175], 0
    v_exp_f32 v86, v102
    v_exp_f32 v87, v103
    v_mfma_f32_16x16x32_bf16 v[112:115], v[64:67], v[200:203], v[112:115]
    v_lshlrev_b32_sdwa v104, 1, v104 dst_sel:DWORD dst_unused:UNUSED_PAD src0_sel:DWORD src1_sel:WORD_1
    v_lshlrev_b32_sdwa v105, 1, v105 dst_sel:DWORD dst_unused:UNUSED_PAD src0_sel:DWORD src1_sel:WORD_1
    ds_read_u16_d16_hi v88, v104
    ds_read_u16_d16_hi v89, v105
    v_mfma_f32_16x16x32_bf16 v[120:123], v[64:67], v[204:207], v[120:123]
    v_lshlrev_b32_sdwa v106, 1, v106 dst_sel:DWORD dst_unused:UNUSED_PAD src0_sel:DWORD src1_sel:WORD_1
    v_lshlrev_b32_sdwa v107, 1, v107 dst_sel:DWORD dst_unused:UNUSED_PAD src0_sel:DWORD src1_sel:WORD_1
    ds_read_u16_d16_hi v90, v106
    ds_read_u16_d16_hi v91, v107
    v_mfma_f32_16x16x32_bf16 v[116:119], v[68:71], v[200:203], v[116:119]
    v_lshlrev_b32_sdwa v108, 1, v108 dst_sel:DWORD dst_unused:UNUSED_PAD src0_sel:DWORD src1_sel:WORD_1
    v_lshlrev_b32_sdwa v109, 1, v109 dst_sel:DWORD dst_unused:UNUSED_PAD src0_sel:DWORD src1_sel:WORD_1
    ds_read_u16_d16_hi v92, v108
    ds_read_u16_d16_hi v93, v109
    v_mfma_f32_16x16x32_bf16 v[124:127], v[68:71], v[204:207], v[124:127]
    v_lshlrev_b32_sdwa v110, 1, v110 dst_sel:DWORD dst_unused:UNUSED_PAD src0_sel:DWORD src1_sel:WORD_1
    v_lshlrev_b32_sdwa v111, 1, v111 dst_sel:DWORD dst_unused:UNUSED_PAD src0_sel:DWORD src1_sel:WORD_1
    ds_read_u16_d16_hi v94, v110
    ds_read_u16_d16_hi v95, v111
    s_setprio 0
    v_add_f32 v80, 1.0, v80
    v_add_f32 v81, 1.0, v81
    v_add_f32 v82, 1.0, v82
    v_add_f32 v83, 1.0, v83
    v_add_f32 v84, 1.0, v84
    v_add_f32 v85, 1.0, v85
    v_add_f32 v86, 1.0, v86
    v_add_f32 v87, 1.0, v87
    s_setprio 1
    v_mfma_f32_16x16x32_bf16 v[112:115], v[48:51], v[232:235], v[112:115]
    v_rcp_f32 v80, v80
    v_mfma_f32_16x16x32_bf16 v[120:123], v[48:51], v[236:239], v[120:123]
    v_rcp_f32 v81, v81
    v_mfma_f32_16x16x32_bf16 v[116:119], v[52:55], v[232:235], v[116:119]
    v_rcp_f32 v82, v82
    v_mfma_f32_16x16x32_bf16 v[124:127], v[52:55], v[236:239], v[124:127]
    v_rcp_f32 v83, v83
    s_waitcnt lgkmcnt(8)
    v_smfmac_f32_16x16x64_bf16 v[152:155], v[20:23], v[32:39], v10 abid:1
    v_rcp_f32 v84, v84
    v_mfma_f32_16x16x32_bf16 v[72:75], v[48:51], v[48:51], v[72:75]
    v_rcp_f32 v85, v85
    v_smfmac_f32_16x16x64_bf16 v[156:159], v[20:23], v[40:47], v10 abid:1
    v_rcp_f32 v86, v86
    ds_read_b64_tr_b16 v[20:21], v14
    ds_read_b64_tr_b16 v[22:23], v15
    v_rcp_f32 v87, v87
    v_mfma_f32_16x16x32_bf16 v[72:75], v[52:55], v[52:55], v[72:75]
    s_setprio 0
    v_mul_f32 v80, v80, v96
    v_mul_f32 v81, v81, v97
    v_mul_f32 v82, v82, v98
    v_mul_f32 v83, v83, v99
    v_mul_f32 v84, v84, v100
    v_mul_f32 v85, v85, v101
    v_mul_f32 v86, v86, v102
    v_mul_f32 v87, v87, v103
    s_setprio 1
    s_cbranch_vccz M_U2
    s_setprio 2
M_U2:
M_H12:
    s_cbranch_execz A_RET
    v_mfma_f32_16x16x32_bf16 v[96:99], v[56:59], v[176:179], 0
    v_lshlrev_b32_sdwa v112, 1, v112 dst_sel:DWORD dst_unused:UNUSED_PAD src0_sel:DWORD src1_sel:WORD_1
    v_lshlrev_b32_sdwa v113, 1, v113 dst_sel:DWORD dst_unused:UNUSED_PAD src0_sel:DWORD src1_sel:WORD_1
    v_mfma_f32_16x16x32_bf16 v[104:107], v[56:59], v[180:183], 0
    ds_read_u16_d16_hi v32, v112
    v_xad_u32 v12, v12, v29, v5
    v_mfma_f32_16x16x32_bf16 v[100:103], v[60:63], v[176:179], 0
    ds_read_u16_d16_hi v33, v113
    v_xad_u32 v13, v13, v29, v5
    v_lshlrev_b32_sdwa v114, 1, v114 dst_sel:DWORD dst_unused:UNUSED_PAD src0_sel:DWORD src1_sel:WORD_1
    v_mfma_f32_16x16x32_bf16 v[108:111], v[60:63], v[180:183], 0
    v_lshlrev_b32_sdwa v115, 1, v115 dst_sel:DWORD dst_unused:UNUSED_PAD src0_sel:DWORD src1_sel:WORD_1
    ds_read_u16_d16_hi v34, v114
    v_mfma_f32_16x16x32_bf16 v[96:99], v[64:67], v[208:211], v[96:99]
    ds_read_u16_d16_hi v35, v115
    v_lshlrev_b32_sdwa v116, 1, v116 dst_sel:DWORD dst_unused:UNUSED_PAD src0_sel:DWORD src1_sel:WORD_1
    v_lshlrev_b32_sdwa v117, 1, v117 dst_sel:DWORD dst_unused:UNUSED_PAD src0_sel:DWORD src1_sel:WORD_1
    v_mfma_f32_16x16x32_bf16 v[104:107], v[64:67], v[212:215], v[104:107]
    ds_read_u16_d16_hi v36, v116
    ds_read_u16_d16_hi v37, v117
    v_mfma_f32_16x16x32_bf16 v[100:103], v[68:71], v[208:211], v[100:103]
    v_lshlrev_b32_sdwa v118, 1, v118 dst_sel:DWORD dst_unused:UNUSED_PAD src0_sel:DWORD src1_sel:WORD_1
    v_lshlrev_b32_sdwa v119, 1, v119 dst_sel:DWORD dst_unused:UNUSED_PAD src0_sel:DWORD src1_sel:WORD_1
    ds_read_u16_d16_hi v38, v118
    v_mfma_f32_16x16x32_bf16 v[108:111], v[68:71], v[212:215], v[108:111]
    ds_read_u16_d16_hi v39, v119
    v_lshlrev_b32_sdwa v120, 1, v120 dst_sel:DWORD dst_unused:UNUSED_PAD src0_sel:DWORD src1_sel:WORD_1
    v_mfma_f32_16x16x32_bf16 v[96:99], v[48:51], v[240:243], v[96:99]
    v_lshlrev_b32_sdwa v121, 1, v121 dst_sel:DWORD dst_unused:UNUSED_PAD src0_sel:DWORD src1_sel:WORD_1
    ds_read_u16_d16_hi v40, v120
    v_mfma_f32_16x16x32_bf16 v[104:107], v[48:51], v[244:247], v[104:107]
    ds_read_u16_d16_hi v41, v121
    v_lshlrev_b32_sdwa v122, 1, v122 dst_sel:DWORD dst_unused:UNUSED_PAD src0_sel:DWORD src1_sel:WORD_1
    v_lshlrev_b32_sdwa v123, 1, v123 dst_sel:DWORD dst_unused:UNUSED_PAD src0_sel:DWORD src1_sel:WORD_1
    v_mfma_f32_16x16x32_bf16 v[100:103], v[52:55], v[240:243], v[100:103]
    ds_read_u16_d16_hi v42, v122
    ds_read_u16_d16_hi v43, v123
    v_mfma_f32_16x16x32_bf16 v[108:111], v[52:55], v[244:247], v[108:111]
    v_lshlrev_b32_sdwa v124, 1, v124 dst_sel:DWORD dst_unused:UNUSED_PAD src0_sel:DWORD src1_sel:WORD_1
    v_lshlrev_b32_sdwa v125, 1, v125 dst_sel:DWORD dst_unused:UNUSED_PAD src0_sel:DWORD src1_sel:WORD_1
    ds_read_u16_d16_hi v44, v124
    s_waitcnt lgkmcnt(13)
    v_smfmac_f32_16x16x64_bf16 v[128:131], v[20:23], v[80:87], v10 abid:1
    ds_read_u16_d16_hi v45, v125
    v_lshlrev_b32_sdwa v126, 1, v126 dst_sel:DWORD dst_unused:UNUSED_PAD src0_sel:DWORD src1_sel:WORD_1
    v_smfmac_f32_16x16x64_bf16 v[132:135], v[20:23], v[88:95], v10 abid:1
    v_lshlrev_b32_sdwa v127, 1, v127 dst_sel:DWORD dst_unused:UNUSED_PAD src0_sel:DWORD src1_sel:WORD_1
    ds_read_u16_d16_hi v46, v126
    ds_read_u16_d16_hi v47, v127
    s_waitcnt vmcnt(5)
    v_mfma_f32_16x16x32_bf16 v[112:115], v[56:59], v[184:187], 0
    v_exp_f32 v80, v96
    ds_read_b128 v[16:19], v6 offset:512
    v_exp_f32 v81, v97
    v_mfma_f32_16x16x32_bf16 v[120:123], v[56:59], v[188:191], 0
    v_exp_f32 v82, v98
    ds_read_b128 v[56:59], v0 offset:0
    v_exp_f32 v83, v99
    v_mfma_f32_16x16x32_bf16 v[116:119], v[60:63], v[184:187], 0
    v_exp_f32 v84, v100
    ds_read_b32 v11, v7 offset:512
    v_exp_f32 v85, v101
    v_mfma_f32_16x16x32_bf16 v[124:127], v[60:63], v[188:191], 0
    v_exp_f32 v86, v102
    ds_read_b128 v[60:63], v0 offset:2048
    v_exp_f32 v87, v103
    v_mfma_f32_16x16x32_bf16 v[112:115], v[64:67], v[216:219], v[112:115]
    v_lshlrev_b32_sdwa v104, 1, v104 dst_sel:DWORD dst_unused:UNUSED_PAD src0_sel:DWORD src1_sel:WORD_1
    v_lshlrev_b32_sdwa v105, 1, v105 dst_sel:DWORD dst_unused:UNUSED_PAD src0_sel:DWORD src1_sel:WORD_1
    ds_read_b32 v14, v8 offset:128
    v_or3_b32 v10, v104, v105, v10
    ds_read_u16_d16_hi v88, v104
    ds_read_u16_d16_hi v89, v105
    v_mfma_f32_16x16x32_bf16 v[120:123], v[64:67], v[220:223], v[120:123]
    v_lshlrev_b32_sdwa v106, 1, v106 dst_sel:DWORD dst_unused:UNUSED_PAD src0_sel:DWORD src1_sel:WORD_1
    v_lshlrev_b32_sdwa v107, 1, v107 dst_sel:DWORD dst_unused:UNUSED_PAD src0_sel:DWORD src1_sel:WORD_1
    ds_read_b128 v[64:67], v1 offset:0
    ds_read_u16_d16_hi v90, v106
    ds_read_u16_d16_hi v91, v107
    v_mfma_f32_16x16x32_bf16 v[116:119], v[68:71], v[216:219], v[116:119]
    v_lshlrev_b32_sdwa v108, 1, v108 dst_sel:DWORD dst_unused:UNUSED_PAD src0_sel:DWORD src1_sel:WORD_1
    v_lshlrev_b32_sdwa v109, 1, v109 dst_sel:DWORD dst_unused:UNUSED_PAD src0_sel:DWORD src1_sel:WORD_1
    ds_read_u16_d16_hi v92, v108
    ds_read_u16_d16_hi v93, v109
    v_mfma_f32_16x16x32_bf16 v[124:127], v[68:71], v[220:223], v[124:127]
    v_lshlrev_b32_sdwa v110, 1, v110 dst_sel:DWORD dst_unused:UNUSED_PAD src0_sel:DWORD src1_sel:WORD_1
    v_lshlrev_b32_sdwa v111, 1, v111 dst_sel:DWORD dst_unused:UNUSED_PAD src0_sel:DWORD src1_sel:WORD_1
    ds_read_b128 v[68:71], v1 offset:2048
    ds_read_u16_d16_hi v94, v110
    ds_read_u16_d16_hi v95, v111
    s_setprio 0
    v_add_f32 v80, 1.0, v80
    v_add_f32 v81, 1.0, v81
    v_add_f32 v82, 1.0, v82
    v_add_f32 v83, 1.0, v83
    v_add_f32 v84, 1.0, v84
    v_add_f32 v85, 1.0, v85
    v_add_f32 v86, 1.0, v86
    v_add_f32 v87, 1.0, v87
    s_setprio 1
    v_mfma_f32_16x16x32_bf16 v[112:115], v[48:51], v[248:251], v[112:115]
    v_rcp_f32 v80, v80
    v_mfma_f32_16x16x32_bf16 v[120:123], v[48:51], v[252:255], v[120:123]
    v_rcp_f32 v81, v81
    ds_read_b128 v[48:51], v12
    v_mfma_f32_16x16x32_bf16 v[116:119], v[52:55], v[248:251], v[116:119]
    v_rcp_f32 v82, v82
    v_mfma_f32_16x16x32_bf16 v[124:127], v[52:55], v[252:255], v[124:127]
    v_rcp_f32 v83, v83
    ds_read_b128 v[52:55], v13
    s_waitcnt lgkmcnt(15)
    v_smfmac_f32_16x16x64_bf16 v[136:139], v[20:23], v[32:39], v10 abid:1
    v_rcp_f32 v84, v84
    v_rcp_f32 v85, v85
    v_smfmac_f32_16x16x64_bf16 v[140:143], v[20:23], v[40:47], v10 abid:1
    v_rcp_f32 v86, v86
    v_rcp_f32 v87, v87
    s_setprio 0
    v_mul_f32 v80, v80, v96
    v_mul_f32 v81, v81, v97
    v_mul_f32 v82, v82, v98
    v_mul_f32 v83, v83, v99
    v_mul_f32 v84, v84, v100
    v_mul_f32 v85, v85, v101
    v_mul_f32 v86, v86, v102
    v_mul_f32 v87, v87, v103
    s_setprio 1
    s_sub_u32 s42, s42, 1
    s_cmp_le_u32 s42, s62
    s_cbranch_scc0 M_LOOP0
M_LX:
    s_cmp_lg_u32 s42, 0
    s_cbranch_scc1 M_LH
    s_nop 1
    v_lshlrev_b32_sdwa v112, 1, v112 dst_sel:DWORD dst_unused:UNUSED_PAD src0_sel:DWORD src1_sel:WORD_1
    v_lshlrev_b32_sdwa v113, 1, v113 dst_sel:DWORD dst_unused:UNUSED_PAD src0_sel:DWORD src1_sel:WORD_1
    ds_read_u16_d16_hi v32, v112
    ds_read_u16_d16_hi v33, v113
    v_lshlrev_b32_sdwa v114, 1, v114 dst_sel:DWORD dst_unused:UNUSED_PAD src0_sel:DWORD src1_sel:WORD_1
    v_lshlrev_b32_sdwa v115, 1, v115 dst_sel:DWORD dst_unused:UNUSED_PAD src0_sel:DWORD src1_sel:WORD_1
    ds_read_u16_d16_hi v34, v114
    ds_read_u16_d16_hi v35, v115
    v_lshlrev_b32_sdwa v116, 1, v116 dst_sel:DWORD dst_unused:UNUSED_PAD src0_sel:DWORD src1_sel:WORD_1
    v_lshlrev_b32_sdwa v117, 1, v117 dst_sel:DWORD dst_unused:UNUSED_PAD src0_sel:DWORD src1_sel:WORD_1
    ds_read_u16_d16_hi v36, v116
    ds_read_u16_d16_hi v37, v117
    v_lshlrev_b32_sdwa v118, 1, v118 dst_sel:DWORD dst_unused:UNUSED_PAD src0_sel:DWORD src1_sel:WORD_1
    v_lshlrev_b32_sdwa v119, 1, v119 dst_sel:DWORD dst_unused:UNUSED_PAD src0_sel:DWORD src1_sel:WORD_1
    ds_read_u16_d16_hi v38, v118
    ds_read_u16_d16_hi v39, v119
    v_lshlrev_b32_sdwa v120, 1, v120 dst_sel:DWORD dst_unused:UNUSED_PAD src0_sel:DWORD src1_sel:WORD_1
M_H13:
    s_cbranch_execz A_RET
    v_lshlrev_b32_sdwa v121, 1, v121 dst_sel:DWORD dst_unused:UNUSED_PAD src0_sel:DWORD src1_sel:WORD_1
    ds_read_u16_d16_hi v40, v120
    ds_read_u16_d16_hi v41, v121
    v_lshlrev_b32_sdwa v122, 1, v122 dst_sel:DWORD dst_unused:UNUSED_PAD src0_sel:DWORD src1_sel:WORD_1
    v_lshlrev_b32_sdwa v123, 1, v123 dst_sel:DWORD dst_unused:UNUSED_PAD src0_sel:DWORD src1_sel:WORD_1
    ds_read_u16_d16_hi v42, v122
    ds_read_u16_d16_hi v43, v123
    v_lshlrev_b32_sdwa v124, 1, v124 dst_sel:DWORD dst_unused:UNUSED_PAD src0_sel:DWORD src1_sel:WORD_1
    v_lshlrev_b32_sdwa v125, 1, v125 dst_sel:DWORD dst_unused:UNUSED_PAD src0_sel:DWORD src1_sel:WORD_1
    ds_read_u16_d16_hi v44, v124
    ds_read_u16_d16_hi v45, v125
    v_smfmac_f32_16x16x64_bf16 v[144:147], v[20:23], v[80:87], v10 abid:1
    v_lshlrev_b32_sdwa v126, 1, v126 dst_sel:DWORD dst_unused:UNUSED_PAD src0_sel:DWORD src1_sel:WORD_1
    v_lshlrev_b32_sdwa v127, 1, v127 dst_sel:DWORD dst_unused:UNUSED_PAD src0_sel:DWORD src1_sel:WORD_1
    s_waitcnt lgkmcnt(15)
    v_smfmac_f32_16x16x64_bf16 v[148:151], v[20:23], v[88:95], v10 abid:1
    ds_read_u16_d16_hi v46, v126
    ds_read_u16_d16_hi v47, v127
    s_branch M_LDONE
M_LH:
    s_nop 1
    s_waitcnt lgkmcnt(15)
    v_mfma_f32_16x16x32_bf16 v[96:99], v[56:59], v[160:163], 0
    v_lshlrev_b32_sdwa v112, 1, v112 dst_sel:DWORD dst_unused:UNUSED_PAD src0_sel:DWORD src1_sel:WORD_1
    v_lshlrev_b32_sdwa v113, 1, v113 dst_sel:DWORD dst_unused:UNUSED_PAD src0_sel:DWORD src1_sel:WORD_1
    ds_read_u16_d16_hi v32, v112
    v_mfma_f32_16x16x32_bf16 v[104:107], v[56:59], v[164:167], 0
    ds_read_u16_d16_hi v33, v113
    v_lshlrev_b32_sdwa v114, 1, v114 dst_sel:DWORD dst_unused:UNUSED_PAD src0_sel:DWORD src1_sel:WORD_1
    v_lshlrev_b32_sdwa v115, 1, v115 dst_sel:DWORD dst_unused:UNUSED_PAD src0_sel:DWORD src1_sel:WORD_1
    ds_read_u16_d16_hi v34, v114
    ds_read_u16_d16_hi v35, v115
    v_lshlrev_b32_sdwa v116, 1, v116 dst_sel:DWORD dst_unused:UNUSED_PAD src0_sel:DWORD src1_sel:WORD_1
    v_lshlrev_b32_sdwa v117, 1, v117 dst_sel:DWORD dst_unused:UNUSED_PAD src0_sel:DWORD src1_sel:WORD_1
    s_waitcnt lgkmcnt(13)
    v_mfma_f32_16x16x32_bf16 v[96:99], v[64:67], v[192:195], v[96:99]
    ds_read_u16_d16_hi v36, v116
    ds_read_u16_d16_hi v37, v117
    v_mfma_f32_16x16x32_bf16 v[104:107], v[64:67], v[196:199], v[104:107]
    v_xor_b32_sdwa v15, v4, v14 dst_sel:DWORD dst_unused:UNUSED_PAD src0_sel:DWORD src1_sel:WORD_1
    v_lshlrev_b32_sdwa v118, 1, v118 dst_sel:DWORD dst_unused:UNUSED_PAD src0_sel:DWORD src1_sel:WORD_1
    v_lshlrev_b32_sdwa v119, 1, v119 dst_sel:DWORD dst_unused:UNUSED_PAD src0_sel:DWORD src1_sel:WORD_1
    ds_read_u16_d16_hi v38, v118
    v_xor_b32_sdwa v14, v4, v14 dst_sel:DWORD dst_unused:UNUSED_PAD src0_sel:DWORD src1_sel:WORD_0
    ds_read_u16_d16_hi v39, v119
    v_lshlrev_b32_sdwa v120, 1, v120 dst_sel:DWORD dst_unused:UNUSED_PAD src0_sel:DWORD src1_sel:WORD_1
    v_lshlrev_b32_sdwa v121, 1, v121 dst_sel:DWORD dst_unused:UNUSED_PAD src0_sel:DWORD src1_sel:WORD_1
    ds_read_u16_d16_hi v40, v120
    s_waitcnt lgkmcnt(10)
    v_mfma_f32_16x16x32_bf16 v[96:99], v[48:51], v[224:227], v[96:99]
    ds_read_u16_d16_hi v41, v121
    v_mfma_f32_16x16x32_bf16 v[104:107], v[48:51], v[228:231], v[104:107]
    v_lshlrev_b32_sdwa v122, 1, v122 dst_sel:DWORD dst_unused:UNUSED_PAD src0_sel:DWORD src1_sel:WORD_1
    v_lshlrev_b32_sdwa v123, 1, v123 dst_sel:DWORD dst_unused:UNUSED_PAD src0_sel:DWORD src1_sel:WORD_1
    ds_read_u16_d16_hi v42, v122
    ds_read_u16_d16_hi v43, v123
    v_lshlrev_b32_sdwa v124, 1, v124 dst_sel:DWORD dst_unused:UNUSED_PAD src0_sel:DWORD src1_sel:WORD_1
    v_lshlrev_b32_sdwa v125, 1, v125 dst_sel:DWORD dst_unused:UNUSED_PAD src0_sel:DWORD src1_sel:WORD_1
    ds_read_u16_d16_hi v44, v124
    ds_read_u16_d16_hi v45, v125
    v_smfmac_f32_16x16x64_bf16 v[144:147], v[20:23], v[80:87], v10 abid:1
    v_lshlrev_b32_sdwa v126, 1, v126 dst_sel:DWORD dst_unused:UNUSED_PAD src0_sel:DWORD src1_sel:WORD_1
    v_lshlrev_b32_sdwa v127, 1, v127 dst_sel:DWORD dst_unused:UNUSED_PAD src0_sel:DWORD src1_sel:WORD_1
    v_smfmac_f32_16x16x64_bf16 v[148:151], v[20:23], v[88:95], v10 abid:1
    ds_read_u16_d16_hi v46, v126
    ds_read_u16_d16_hi v47, v127
    v_mfma_f32_16x16x32_bf16 v[112:115], v[56:59], v[168:171], 0
    v_exp_f32 v80, v96
    v_exp_f32 v81, v97
    v_mfma_f32_16x16x32_bf16 v[120:123], v[56:59], v[172:175], 0
    v_exp_f32 v82, v98
    v_exp_f32 v83, v99
    v_mfma_f32_16x16x32_bf16 v[112:115], v[64:67], v[200:203], v[112:115]
    v_lshlrev_b32_sdwa v104, 1, v104 dst_sel:DWORD dst_unused:UNUSED_PAD src0_sel:DWORD src1_sel:WORD_1
    v_lshlrev_b32_sdwa v105, 1, v105 dst_sel:DWORD dst_unused:UNUSED_PAD src0_sel:DWORD src1_sel:WORD_1
    ds_read_u16_d16_hi v88, v104
    ds_read_u16_d16_hi v89, v105
    v_mfma_f32_16x16x32_bf16 v[120:123], v[64:67], v[204:207], v[120:123]
    v_lshlrev_b32_sdwa v106, 1, v106 dst_sel:DWORD dst_unused:UNUSED_PAD src0_sel:DWORD src1_sel:WORD_1
    v_lshlrev_b32_sdwa v107, 1, v107 dst_sel:DWORD dst_unused:UNUSED_PAD src0_sel:DWORD src1_sel:WORD_1
    ds_read_u16_d16_hi v90, v106
    ds_read_u16_d16_hi v91, v107
    s_setprio 0
    v_add_f32 v80, 1.0, v80
    v_add_f32 v81, 1.0, v81
    v_add_f32 v82, 1.0, v82
    v_add_f32 v83, 1.0, v83
    s_setprio 1
    v_mfma_f32_16x16x32_bf16 v[112:115], v[48:51], v[232:235], v[112:115]
    v_rcp_f32 v80, v80
    v_mfma_f32_16x16x32_bf16 v[120:123], v[48:51], v[236:239], v[120:123]
    v_rcp_f32 v81, v81
    v_rcp_f32 v82, v82
    v_rcp_f32 v83, v83
    s_waitcnt lgkmcnt(12)
    v_smfmac_f32_16x16x64_bf16 v[152:155], v[20:23], v[32:39], v10 abid:1
    v_mfma_f32_16x16x32_bf16 v[72:75], v[48:51], v[48:51], v[72:75]
    s_waitcnt lgkmcnt(4)
    v_smfmac_f32_16x16x64_bf16 v[156:159], v[20:23], v[40:47], v10 abid:1
    ds_read_b64_tr_b16 v[20:21], v14
    ds_read_b64_tr_b16 v[22:23], v15
    s_setprio 0
    v_mul_f32 v80, v80, v96
    v_mul_f32 v81, v81, v97
    v_mul_f32 v82, v82, v98
    v_mul_f32 v83, v83, v99
    s_setprio 1
    s_cbranch_vccz M_U5
    s_setprio 2
M_U5:
    v_mfma_f32_16x16x32_bf16 v[96:99], v[56:59], v[176:179], 0
    v_lshlrev_b32_sdwa v112, 1, v112 dst_sel:DWORD dst_unused:UNUSED_PAD src0_sel:DWORD src1_sel:WORD_1
    v_lshlrev_b32_sdwa v113, 1, v113 dst_sel:DWORD dst_unused:UNUSED_PAD src0_sel:DWORD src1_sel:WORD_1
    v_mfma_f32_16x16x32_bf16 v[104:107], v[56:59], v[180:183], 0
    ds_read_u16_d16_hi v32, v112
    ds_read_u16_d16_hi v33, v113
    v_lshlrev_b32_sdwa v114, 1, v114 dst_sel:DWORD dst_unused:UNUSED_PAD src0_sel:DWORD src1_sel:WORD_1
    v_lshlrev_b32_sdwa v115, 1, v115 dst_sel:DWORD dst_unused:UNUSED_PAD src0_sel:DWORD src1_sel:WORD_1
    ds_read_u16_d16_hi v34, v114
    v_mfma_f32_16x16x32_bf16 v[96:99], v[64:67], v[208:211], v[96:99]
    ds_read_u16_d16_hi v35, v115
    v_mfma_f32_16x16x32_bf16 v[104:107], v[64:67], v[212:215], v[104:107]
    v_lshlrev_b32_sdwa v120, 1, v120 dst_sel:DWORD dst_unused:UNUSED_PAD src0_sel:DWORD src1_sel:WORD_1
    v_mfma_f32_16x16x32_bf16 v[96:99], v[48:51], v[240:243], v[96:99]
    v_lshlrev_b32_sdwa v121, 1, v121 dst_sel:DWORD dst_unused:UNUSED_PAD src0_sel:DWORD src1_sel:WORD_1
    ds_read_u16_d16_hi v40, v120
    v_mfma_f32_16x16x32_bf16 v[104:107], v[48:51], v[244:247], v[104:107]
    ds_read_u16_d16_hi v41, v121
    v_lshlrev_b32_sdwa v122, 1, v122 dst_sel:DWORD dst_unused:UNUSED_PAD src0_sel:DWORD src1_sel:WORD_1
    v_lshlrev_b32_sdwa v123, 1, v123 dst_sel:DWORD dst_unused:UNUSED_PAD src0_sel:DWORD src1_sel:WORD_1
    ds_read_u16_d16_hi v42, v122
    ds_read_u16_d16_hi v43, v123
    s_waitcnt lgkmcnt(8)
    v_smfmac_f32_16x16x64_bf16 v[128:131], v[20:23], v[80:87], v10 abid:1
    v_smfmac_f32_16x16x64_bf16 v[132:135], v[20:23], v[88:95], v10 abid:1
    v_mfma_f32_16x16x32_bf16 v[112:115], v[56:59], v[184:187], 0
    v_exp_f32 v80, v96
    v_exp_f32 v81, v97
    v_mfma_f32_16x16x32_bf16 v[120:123], v[56:59], v[188:191], 0
    v_exp_f32 v82, v98
    v_exp_f32 v83, v99
    v_mfma_f32_16x16x32_bf16 v[112:115], v[64:67], v[216:219], v[112:115]
    v_lshlrev_b32_sdwa v104, 1, v104 dst_sel:DWORD dst_unused:UNUSED_PAD src0_sel:DWORD src1_sel:WORD_1
    v_lshlrev_b32_sdwa v105, 1, v105 dst_sel:DWORD dst_unused:UNUSED_PAD src0_sel:DWORD src1_sel:WORD_1
    v_or3_b32 v10, v104, v105, v10
    ds_read_u16_d16_hi v88, v104
    ds_read_u16_d16_hi v89, v105
M_H14:
    s_cbranch_execz A_RET
    v_mfma_f32_16x16x32_bf16 v[120:123], v[64:67], v[220:223], v[120:123]
    v_lshlrev_b32_sdwa v106, 1, v106 dst_sel:DWORD dst_unused:UNUSED_PAD src0_sel:DWORD src1_sel:WORD_1
    v_lshlrev_b32_sdwa v107, 1, v107 dst_sel:DWORD dst_unused:UNUSED_PAD src0_sel:DWORD src1_sel:WORD_1
    ds_read_u16_d16_hi v90, v106
    ds_read_u16_d16_hi v91, v107
    s_setprio 0
    v_add_f32 v80, 1.0, v80
    v_add_f32 v81, 1.0, v81
    v_add_f32 v82, 1.0, v82
    v_add_f32 v83, 1.0, v83
    s_setprio 1
    v_mfma_f32_16x16x32_bf16 v[112:115], v[48:51], v[248:251], v[112:115]
    v_rcp_f32 v80, v80
    v_mfma_f32_16x16x32_bf16 v[120:123], v[48:51], v[252:255], v[120:123]
    v_rcp_f32 v81, v81
    v_rcp_f32 v82, v82
    v_rcp_f32 v83, v83
    s_waitcnt lgkmcnt(8)
    v_smfmac_f32_16x16x64_bf16 v[136:139], v[20:23], v[32:39], v10 abid:1
    s_waitcnt lgkmcnt(4)
    v_smfmac_f32_16x16x64_bf16 v[140:143], v[20:23], v[40:47], v10 abid:1
    s_setprio 0
    v_mul_f32 v80, v80, v96
    v_mul_f32 v81, v81, v97
    v_mul_f32 v82, v82, v98
    v_mul_f32 v83, v83, v99
    s_setprio 1
    v_lshlrev_b32_sdwa v112, 1, v112 dst_sel:DWORD dst_unused:UNUSED_PAD src0_sel:DWORD src1_sel:WORD_1
    v_lshlrev_b32_sdwa v113, 1, v113 dst_sel:DWORD dst_unused:UNUSED_PAD src0_sel:DWORD src1_sel:WORD_1
    ds_read_u16_d16_hi v32, v112
    ds_read_u16_d16_hi v33, v113
    v_lshlrev_b32_sdwa v114, 1, v114 dst_sel:DWORD dst_unused:UNUSED_PAD src0_sel:DWORD src1_sel:WORD_1
    v_lshlrev_b32_sdwa v115, 1, v115 dst_sel:DWORD dst_unused:UNUSED_PAD src0_sel:DWORD src1_sel:WORD_1
    ds_read_u16_d16_hi v34, v114
    ds_read_u16_d16_hi v35, v115
    v_lshlrev_b32_sdwa v120, 1, v120 dst_sel:DWORD dst_unused:UNUSED_PAD src0_sel:DWORD src1_sel:WORD_1
    v_lshlrev_b32_sdwa v121, 1, v121 dst_sel:DWORD dst_unused:UNUSED_PAD src0_sel:DWORD src1_sel:WORD_1
    ds_read_u16_d16_hi v40, v120
    ds_read_u16_d16_hi v41, v121
    v_lshlrev_b32_sdwa v122, 1, v122 dst_sel:DWORD dst_unused:UNUSED_PAD src0_sel:DWORD src1_sel:WORD_1
    v_lshlrev_b32_sdwa v123, 1, v123 dst_sel:DWORD dst_unused:UNUSED_PAD src0_sel:DWORD src1_sel:WORD_1
    ds_read_u16_d16_hi v42, v122
    ds_read_u16_d16_hi v43, v123
    v_smfmac_f32_16x16x64_bf16 v[144:147], v[20:23], v[80:87], v10 abid:1
    s_waitcnt lgkmcnt(8)
    v_smfmac_f32_16x16x64_bf16 v[148:151], v[20:23], v[88:95], v10 abid:1
M_LDONE:
    v_maximum3_f32 v31, v72, v73, v74
    v_and_b32 v30, 0x1800, v10
    v_maximum3_f32 v31, v31, v75, v75
    v_cmp_ne_u32 vcc, 0, v30
    v_cmp_ngt_f32 s[58:59], s63, v31
    s_setprio 0
    s_cmp_gt_u32 s41, 2048
    s_cbranch_vccz M_RARE
    s_cselect_b32 s44, 1, s58
    s_or_b32 s44, s44, s59
    s_cbranch_scc1 M_RARE
M_EPI:
    ds_read_b128 v[48:51], v25
    ds_read_b128 v[56:59], v26 offset:0
    ds_read_b128 v[60:63], v26 offset:16
    ds_read_b128 v[64:67], v26 offset:128
    ds_read_b128 v[68:71], v26 offset:144
    v_mov_b32 v74, 0
    v_mov_b32 v75, 0
    ds_read_b128 v[160:163], v24 offset:49152
    v_mul_f32 v128, 0xbf31f21b, v128
    v_mul_f32 v129, 0xbf31f21b, v129
    ds_read_b128 v[164:167], v24 offset:50176
    v_mul_f32 v130, 0xbf31f21b, v130
    v_mul_f32 v131, 0xbf31f21b, v131
    ds_read_b128 v[168:171], v24 offset:51200
    v_cvt_pk_bf16_f32 v224, v128, v129
    v_cvt_pk_bf16_f32 v225, v130, v131
    ds_read_b128 v[172:175], v24 offset:52224
    v_cvt_pk_bf16_f32 v226, v132, v133
    v_cvt_pk_bf16_f32 v227, v134, v135
    ds_read_b128 v[176:179], v24 offset:53248
    v_cvt_pk_bf16_f32 v228, v136, v137
    v_cvt_pk_bf16_f32 v229, v138, v139
    ds_read_b128 v[180:183], v24 offset:54272
    v_cvt_pk_bf16_f32 v230, v140, v141
    v_cvt_pk_bf16_f32 v231, v142, v143
    v_mfma_f32_16x16x32_bf16 v[96:99], v[224:227], v[76:79], 0
    v_mul_f32 v144, 0xbf31f21b, v144
    v_mul_f32 v145, 0xbf31f21b, v145
    v_mul_f32 v146, 0xbf31f21b, v146
    v_mfma_f32_16x16x32_bf16 v[100:103], v[224:227], v[74:77], 0
    v_mul_f32 v147, 0xbf31f21b, v147
    v_cvt_pk_bf16_f32 v232, v144, v145
    v_cvt_pk_bf16_f32 v233, v146, v147
    v_mfma_f32_16x16x32_bf16 v[104:107], v[228:231], v[76:79], 0
    v_cvt_pk_bf16_f32 v234, v148, v149
    v_cvt_pk_bf16_f32 v235, v150, v151
    ds_read_b128 v[184:187], v24 offset:55296
    v_mfma_f32_16x16x32_bf16 v[108:111], v[228:231], v[74:77], 0
    ds_read_b128 v[188:191], v24 offset:56320
    s_waitcnt lgkmcnt(8)
    v_smfmac_f32_16x16x64_bf16 v[152:155], v[20:23], v[32:39], v10 abid:1
    v_add3_u32 v48, v48, v49, v50
    v_add_u32 v48, v48, v51
    ds_read_b128 v[192:195], v24 offset:57344
    v_smfmac_f32_16x16x64_bf16 v[156:159], v[20:23], v[40:47], v10 abid:1
    v_cvt_f32_u32 v48, v48
    v_cvt_pk_bf16_f32 v240, v96, v97
    v_cvt_pk_bf16_f32 v241, v98, v99
    v_mfma_f32_16x16x32_bf16 v[112:115], v[232:235], v[76:79], 0
    v_cvt_pk_bf16_f32 v242, v100, v101
    v_cvt_pk_bf16_f32 v243, v102, v103
    ds_read_b128 v[196:199], v24 offset:58368
    v_mfma_f32_16x16x32_bf16 v[116:119], v[232:235], v[74:77], 0
    v_mul_f32 v56, v48, v56
    v_mul_f32 v57, v48, v57
    v_mul_f32 v58, v48, v58
    v_mul_f32 v59, v48, v59
    v_cvt_pk_bf16_f32 v236, v152, v153
    v_cvt_pk_bf16_f32 v237, v154, v155
    v_cvt_pk_bf16_f32 v238, v156, v157
    v_cvt_pk_bf16_f32 v239, v158, v159
    s_nop 1
    v_mfma_f32_16x16x32_bf16 v[120:123], v[236:239], v[76:79], 0
    ds_read_b128 v[200:203], v24 offset:59392
    v_mul_f32 v60, v48, v60
    v_mul_f32 v61, v48, v61
    v_mul_f32 v62, v48, v62
    v_mul_f32 v63, v48, v63
    v_mfma_f32_16x16x32_bf16 v[124:127], v[236:239], v[74:77], 0
    ds_read_b128 v[204:207], v24 offset:60416
    v_mul_f32 v64, v48, v64
    v_mul_f32 v65, v48, v65
    v_mul_f32 v66, v48, v66
    v_mul_f32 v67, v48, v67
    s_waitcnt lgkmcnt(4)
    v_mfma_f32_16x16x32_bf16 v[56:59], v[160:163], v[240:243], v[56:59]
    ds_read_b128 v[208:211], v24 offset:61440
    v_mul_f32 v68, v48, v68
    v_mul_f32 v69, v48, v69
    v_mul_f32 v70, v48, v70
    v_mul_f32 v71, v48, v71
    v_mfma_f32_16x16x32_bf16 v[60:63], v[164:167], v[240:243], v[60:63]
    ds_read_b128 v[212:215], v24 offset:62464
    v_cvt_pk_bf16_f32 v244, v104, v105
    v_cvt_pk_bf16_f32 v245, v106, v107
    v_mfma_f32_16x16x32_bf16 v[64:67], v[168:171], v[240:243], v[64:67]
    ds_read_b128 v[216:219], v24 offset:63488
    v_cvt_pk_bf16_f32 v246, v108, v109
    v_cvt_pk_bf16_f32 v247, v110, v111
    v_mfma_f32_16x16x32_bf16 v[68:71], v[172:175], v[240:243], v[68:71]
    ds_read_b128 v[220:223], v24 offset:64512
    v_cvt_pk_bf16_f32 v248, v112, v113
    v_cvt_pk_bf16_f32 v249, v114, v115
    v_mfma_f32_16x16x32_bf16 v[56:59], v[176:179], v[244:247], v[56:59]
    v_cvt_pk_bf16_f32 v250, v116, v117
M_H15:
    s_cbranch_execz A_RET
    v_cvt_pk_bf16_f32 v251, v118, v119
    v_mfma_f32_16x16x32_bf16 v[60:63], v[180:183], v[244:247], v[60:63]
    v_cvt_pk_bf16_f32 v252, v120, v121
    v_cvt_pk_bf16_f32 v253, v122, v123
    v_mfma_f32_16x16x32_bf16 v[64:67], v[184:187], v[244:247], v[64:67]
    v_cvt_pk_bf16_f32 v254, v124, v125
    v_cvt_pk_bf16_f32 v255, v126, v127
    v_mfma_f32_16x16x32_bf16 v[68:71], v[188:191], v[244:247], v[68:71]
    s_waitcnt lgkmcnt(0)
    v_mfma_f32_16x16x32_bf16 v[56:59], v[192:195], v[248:251], v[56:59]
    v_mfma_f32_16x16x32_bf16 v[60:63], v[196:199], v[248:251], v[60:63]
    v_mfma_f32_16x16x32_bf16 v[64:67], v[200:203], v[248:251], v[64:67]
    v_mfma_f32_16x16x32_bf16 v[68:71], v[204:207], v[248:251], v[68:71]
    v_mfma_f32_16x16x32_bf16 v[56:59], v[208:211], v[252:255], v[56:59]
    v_mfma_f32_16x16x32_bf16 v[60:63], v[212:215], v[252:255], v[60:63]
    v_mfma_f32_16x16x32_bf16 v[64:67], v[216:219], v[252:255], v[64:67]
    v_mfma_f32_16x16x32_bf16 v[68:71], v[220:223], v[252:255], v[68:71]
    s_nop 4
    v_cvt_pk_bf16_f32 v224, v56, v57
    v_cvt_pk_bf16_f32 v225, v58, v59
    v_cvt_pk_bf16_f32 v226, v60, v61
    v_cvt_pk_bf16_f32 v227, v62, v63
    buffer_store_dwordx4 v[224:227], v27, s[32:35], 0 offen offset:0 sc1
    v_cvt_pk_bf16_f32 v228, v64, v65
    v_cvt_pk_bf16_f32 v229, v66, v67
    v_cvt_pk_bf16_f32 v230, v68, v69
    v_cvt_pk_bf16_f32 v231, v70, v71
    buffer_store_dwordx4 v[228:231], v27, s[32:35], 0 offen offset:64 sc1
M_END:
    s_endpgm
A_SLOW:
    v_mov_b32 v32, 0
    v_mov_b32 v33, 0
    v_mov_b32 v34, 0
    v_mov_b32 v35, 0
    v_add_u32 v36, 73728, v161
    ds_write_b128 v36, v[32:35]
    s_waitcnt lgkmcnt(0)
    s_barrier
    s_mov_b64 exec, s[58:59]
    s_cbranch_execz A_T2
    v_mov_b32 v32, 1
    v_mul_u32_u24 v180, 5368, v164
    v_lshrrev_b32 v180, 14, v180
    v_and_b32 v180, 0x1ffc, v180
    v_add_u32 v180, 73728, v180
    ds_add_rtn_u32 v204, v180, v32
    v_mul_u32_u24 v181, 5368, v165
    v_lshrrev_b32 v181, 14, v181
    v_and_b32 v181, 0x1ffc, v181
    v_add_u32 v181, 73728, v181
    ds_add_rtn_u32 v205, v181, v32
    v_mul_u32_u24 v182, 5368, v166
    v_lshrrev_b32 v182, 14, v182
    v_and_b32 v182, 0x1ffc, v182
    v_add_u32 v182, 73728, v182
    ds_add_rtn_u32 v206, v182, v32
    v_mul_u32_u24 v183, 5368, v167
    v_lshrrev_b32 v183, 14, v183
    v_and_b32 v183, 0x1ffc, v183
    v_add_u32 v183, 73728, v183
    ds_add_rtn_u32 v207, v183, v32
    v_mul_u32_u24 v184, 5368, v168
    v_lshrrev_b32 v184, 14, v184
    v_and_b32 v184, 0x1ffc, v184
    v_add_u32 v184, 73728, v184
    ds_add_rtn_u32 v208, v184, v32
    v_mul_u32_u24 v185, 5368, v169
    v_lshrrev_b32 v185, 14, v185
    v_and_b32 v185, 0x1ffc, v185
    v_add_u32 v185, 73728, v185
    ds_add_rtn_u32 v209, v185, v32
    v_mul_u32_u24 v186, 5368, v170
    v_lshrrev_b32 v186, 14, v186
    v_and_b32 v186, 0x1ffc, v186
    v_add_u32 v186, 73728, v186
    ds_add_rtn_u32 v210, v186, v32
    v_mul_u32_u24 v187, 5368, v171
    v_lshrrev_b32 v187, 14, v187
    v_and_b32 v187, 0x1ffc, v187
    v_add_u32 v187, 73728, v187
    ds_add_rtn_u32 v211, v187, v32
A_T2:
    s_mov_b64 exec, -1
    s_waitcnt lgkmcnt(0)
    s_barrier
    s_cmp_lt_u32 s36, 4
    s_cbranch_scc1 A_T3
    v_subrev_u32 v32, 256, v160
    v_lshlrev_b32 v33, 5, v32
    v_add_u32 v33, 73728, v33
    ds_read_b128 v[96:99], v33
    ds_read_b128 v[100:103], v33 offset:16
    v_mul_u32_u24 v34, 160, v32
    v_add_u32 v34, 8192, v34
    v_add_u32 v105, 4, v34
    v_lshlrev_b32 v35, 2, v32
    s_waitcnt lgkmcnt(0)
    v_lshl_add_u32 v106, v96, 2, v105
    v_lshl_add_u32 v107, v97, 2, v106
    v_lshl_add_u32 v108, v98, 2, v107
    v_lshl_add_u32 v109, v99, 2, v108
    v_lshl_add_u32 v110, v100, 2, v109
    v_lshl_add_u32 v111, v101, 2, v110
    v_lshl_add_u32 v112, v102, 2, v111
    v_lshl_add_u32 v113, v103, 2, v112
    v_or3_b32 v36, v96, v97, v98
    v_or3_b32 v36, v36, v99, v100
    v_or3_b32 v36, v36, v101, v102
    v_or_b32 v36, v36, v103
    v_sub_u32 v37, v113, v105
    v_lshlrev_b32 v36, 4, v36
    v_and_b32 v36, -256, v36
    v_add_u32 v36, v36, v37
    v_mov_b32 v104, v96
    v_cmp_lt_u32 vcc, 124, v36
    v_lshl_or_b32 v104, v97, 4, v104
    v_lshl_or_b32 v104, v98, 8, v104
    v_lshl_or_b32 v104, v99, 12, v104
    v_lshl_or_b32 v104, v100, 16, v104
    v_lshl_or_b32 v104, v101, 20, v104
    v_lshl_or_b32 v104, v102, 24, v104
    v_lshl_or_b32 v104, v103, 28, v104
    s_cbranch_vccz A_NOESC
    s_mov_b64 exec, vcc
    v_mov_b32 v36, 64512
    ds_add_rtn_u32 v36, v36, v37
    v_mov_b32 v104, -1
    s_waitcnt lgkmcnt(0)
    v_sub_u32 v36, v36, v105
    v_add_u32 v36, 192, v36
    v_add_u32 v105, v105, v36
    v_add_u32 v106, v106, v36
    v_add_u32 v107, v107, v36
    v_add_u32 v108, v108, v36
    v_add_u32 v109, v109, v36
    v_add_u32 v110, v110, v36
    v_add_u32 v111, v111, v36
    v_add_u32 v112, v112, v36
    v_add_u32 v113, v113, v36
    ds_write_b128 v34, v[104:107]
    ds_write_b128 v34, v[108:111] offset:16
    ds_write_b64 v34, v[112:113] offset:32
    v_add_u32 v105, 48960, v105
    v_add_u32 v106, 48960, v106
    v_add_u32 v107, 48960, v107
    v_add_u32 v108, 48960, v108
    v_add_u32 v109, 48960, v109
    v_add_u32 v110, 48960, v110
    v_add_u32 v111, 48960, v111
    v_add_u32 v112, 48960, v112
    s_mov_b64 exec, -1
A_NOESC:
    v_mov_b32 v96, v105
    v_mov_b32 v97, v106
    v_mov_b32 v98, v107
    v_mov_b32 v99, v108
    v_mov_b32 v100, v109
    v_mov_b32 v101, v110
    v_mov_b32 v102, v111
    v_mov_b32 v103, v112
    ds_write_b128 v33, v[96:99]
    ds_write_b128 v33, v[100:103] offset:16
    ds_write_b32 v35, v37 offset:61952
    ds_write_b32 v34, v104
A_T3:
    s_waitcnt lgkmcnt(0)
    s_barrier
    s_mov_b64 exec, s[58:59]
    s_cbranch_execz A_T4
    ds_read_b32 v180, v180
    ds_read_b32 v181, v181
    ds_read_b32 v182, v182
    ds_read_b32 v183, v183
    ds_read_b32 v184, v184
    ds_read_b32 v185, v185
    ds_read_b32 v186, v186
    ds_read_b32 v187, v187
    s_waitcnt lgkmcnt(7)
    v_lshl_add_u32 v180, v204, 2, v180
    ds_write_b32 v180, v172
    s_waitcnt lgkmcnt(7)
    v_lshl_add_u32 v181, v205, 2, v181
    ds_write_b32 v181, v173
    s_waitcnt lgkmcnt(7)
    v_lshl_add_u32 v182, v206, 2, v182
    ds_write_b32 v182, v174
    s_waitcnt lgkmcnt(7)
    v_lshl_add_u32 v183, v207, 2, v183
    ds_write_b32 v183, v175
    s_waitcnt lgkmcnt(7)
    v_lshl_add_u32 v184, v208, 2, v184
    ds_write_b32 v184, v176
    s_waitcnt lgkmcnt(7)
    v_lshl_add_u32 v185, v209, 2, v185
    ds_write_b32 v185, v177
    s_waitcnt lgkmcnt(7)
    v_lshl_add_u32 v186, v210, 2, v186
    ds_write_b32 v186, v178
    s_waitcnt lgkmcnt(7)
    v_lshl_add_u32 v187, v211, 2, v187
    ds_write_b32 v187, v179
A_T4:
    s_mov_b64 exec, -1
    ds_read_b32 v232, v228 offset:61952
    ds_read_b32 v233, v228 offset:62016
    s_mov_b32 s41, 1
    s_mov_b64 s[60:61], 0
    s_mov_b64 s[52:53], s[58:59]
    s_waitcnt lgkmcnt(0)
    s_barrier
    ds_read_b128 v[240:243], v229 offset:8192
    ds_read_b128 v[244:247], v229 offset:10752
    ds_read_b128 v[248:251], v229 offset:8256
    ds_read_b128 v[252:255], v229 offset:10816
    s_branch A_OUT
A_SPARE:
    s_cmp_eq_u32 s36, 7
    s_cbranch_scc1 A_W6
A_SP1:
    s_lshl_b32 s38, s36, 12
    s_add_u32 m0, s38, 122880
    s_nop 0
    buffer_load_dwordx4 v77, s[24:27], s38 offen offset:2048 lds
    buffer_load_dwordx4 v77, s[24:27], s38 offen offset:3072 lds
    s_cmp_eq_u32 s36, 7
    s_cbranch_scc1 A_W7
A_SP2:
    v_mov_b32 v32, 0
    v_mov_b32 v33, 0xffff
    v_mov_b32 v34, 0
    v_mov_b32 v35, 0
    buffer_store_dwordx4 v[32:35], v230, s[20:23], s39 offen offset:0 sc1
    buffer_store_dwordx4 v[32:35], v230, s[20:23], s39 offen offset:1024 sc1
    v_mov_b32 v232, 0x7ffffff0
    v_mov_b32 v233, 0x7ffffff0
    s_mov_b32 s0, 0
    s_waitcnt vmcnt(2)
    s_branch A_S5
A_LATE:
    s_cmp_lg_u32 s36, 7
    s_cbranch_scc1 A_LT2
    s_waitcnt vmcnt(0)
A_FLG:
    v_readfirstlane_b32 s44, v94
    s_sub_u32 s9, s9, 1
    s_cmp_lg_u32 s44, 0
    s_cbranch_scc1 A_LT1
    s_cmp_eq_u32 s9, 0
    s_cbranch_scc1 A_BAD
    buffer_load_dword v94, off, s[4:7], 0 sc1
    s_waitcnt vmcnt(0)
    s_branch A_FLG
A_BAD:
    ds_write_b32 v92, v92 offset:16
    s_mov_b32 s10, 0
A_LT1:
    v_mov_b32 v90, s10
    ds_write_b32 v92, v90 offset:20
A_LT2:
    s_waitcnt lgkmcnt(0)
    s_barrier
    ds_read_b32 v90, v92 offset:20
    s_waitcnt lgkmcnt(0)
    s_branch A_ARR
M_ROUND:
    s_waitcnt vmcnt(0) lgkmcnt(0)
    v_lshlrev_b32 v24, 4, v28
    v_add_u32 v24, 159936, v24
    ds_read_b128 v[32:35], v24
    v_lshl_add_u32 v20, v28, 5, s47
    v_lshl_add_u32 v21, v28, 4, s47
    v_mov_b32 v96, 0
    v_mov_b32 v97, 0
    v_mov_b32 v98, 0
    v_mov_b32 v99, 0
    ds_write_b128 v20, v[96:99]
    ds_write_b128 v20, v[96:99] offset:16
    v_lshrrev_b32 v19, 3, v28
    v_lshl_add_u32 v6, v19, 4, s47
    v_and_b32 v31, 3, v28
    v_bfe_u32 v30, v28, 3, 1
    v_lshl_or_b32 v31, v30, 2, v31
    v_bfe_u32 v30, v28, 4, 1
    v_lshl_or_b32 v31, v31, 1, v30
    v_bfe_u32 v30, v28, 2, 1
    v_lshl_or_b32 v31, v31, 1, v30
    s_add_u32 s50, s47, 2048
    s_add_u32 s45, s47, 4096
    v_lshl_add_u32 v7, v31, 2, s50
    v_and_b32 v31, 29, v31
    v_lshl_add_u32 v9, v31, 1, s45
    v_bfe_u32 v31, v28, 2, 3
    v_lshrrev_b32 v30, 5, v28
    v_lshl_add_u32 v31, v31, 1, v30
    v_lshl_add_u32 v8, v31, 2, s45
    s_mov_b32 exec_hi, 0
    v_mov_b32 v9, 157248
    s_mov_b32 exec_hi, -1
    s_waitcnt lgkmcnt(0)
    v_dot8_u32_u4 v80, v32, s53, 0
    v_dot8_u32_u4 v81, v33, s53, 0
    v_dot8_u32_u4 v82, v34, s53, 0
    v_dot8_u32_u4 v83, v35, s53, 0
M_GEN:
    s_movk_i32 s31, 64
    s_waitcnt vmcnt(0)
    v_dot8_u32_u4 v36, v32, s52, 4
    v_dot8_u32_u4 v37, v33, s52, 4
    v_dot8_u32_u4 v38, v34, s52, 4
    v_dot8_u32_u4 v39, v35, s52, 4
    v_lshlrev_b32 v92, 16, v28
    s_add_u32 s44, s49, s54
    v_cmp_eq_u32 vcc, -1, v32
    s_nop 1
    s_mov_b64 exec, vcc
    s_cbranch_execz M_ESC0
    buffer_load_dword v36, v92, s[20:23], s44 offen offset:4 sc1
    buffer_load_dword v80, v92, s[20:23], s44 offen offset:8 sc1
    s_waitcnt vmcnt(0)
    v_sub_u32 v80, v80, v36
M_ESC0:
    s_add_u32 s44, s44, 16384
    s_mov_b64 exec, -1
    v_cmp_eq_u32 vcc, -1, v33
    s_nop 1
    s_mov_b64 exec, vcc
    s_cbranch_execz M_ESC1
    buffer_load_dword v37, v92, s[20:23], s44 offen offset:4 sc1
    buffer_load_dword v81, v92, s[20:23], s44 offen offset:8 sc1
    s_waitcnt vmcnt(0)
    v_sub_u32 v81, v81, v37
M_ESC1:
    s_add_u32 s44, s44, 16384
    s_mov_b64 exec, -1
    v_cmp_eq_u32 vcc, -1, v34
    s_nop 1
    s_mov_b64 exec, vcc
    s_cbranch_execz M_ESC2
    buffer_load_dword v38, v92, s[20:23], s44 offen offset:4 sc1
    buffer_load_dword v82, v92, s[20:23], s44 offen offset:8 sc1
    s_waitcnt vmcnt(0)
    v_sub_u32 v82, v82, v38
M_ESC2:
    s_add_u32 s44, s44, 16384
    s_mov_b64 exec, -1
    v_cmp_eq_u32 vcc, -1, v35
    s_nop 1
    s_mov_b64 exec, vcc
    s_cbranch_execz M_ESC3
    buffer_load_dword v39, v92, s[20:23], s44 offen offset:4 sc1
    buffer_load_dword v83, v92, s[20:23], s44 offen offset:8 sc1
    s_waitcnt vmcnt(0)
    v_sub_u32 v83, v83, v39
M_ESC3:
    s_add_u32 s44, s44, 16384
    s_mov_b64 exec, -1
    v_add_u32 v86, v80, v81
    v_add_u32 v87, v86, v82
    v_add_u32 v92, v87, v83
    v_mov_b32 v93, v92
    s_nop 1
    v_add_u32_dpp v93, v93, v93 row_shr:1 row_mask:0xf bank_mask:0xf
    s_nop 1
    v_add_u32_dpp v93, v93, v93 row_shr:2 row_mask:0xf bank_mask:0xf
    s_nop 1
    v_add_u32_dpp v93, v93, v93 row_shr:4 row_mask:0xf bank_mask:0xf
    s_nop 1
    v_add_u32_dpp v93, v93, v93 row_shr:8 row_mask:0xf bank_mask:0xf
    s_nop 1
    v_add_u32_dpp v93, v93, v93 row_bcast:15 row_mask:0xa bank_mask:0xf
    s_nop 1
    v_add_u32_dpp v93, v93, v93 row_bcast:31 row_mask:0xc bank_mask:0xf
    v_sub_u32 v84, v93, v92
    v_readlane_b32 s41, v93, 63
    v_add_u32 v85, v84, v80
    v_add_u32 v86, v84, v86
    v_add_u32 v87, v84, v87
    v_lshlrev_b32 v92, 16, v28
    s_movk_i32 s44, 2048
    s_min_u32 s41, s41, 3200000
    v_add_u32 v88, v92, v36
    v_sub_u32 v88, v88, v84
    v_add_u32 v92, 0x4000, v92
    v_subrev_u32 v84, s40, v84
    v_med3_i32 v84, v84, 0, s44
    v_add_u32 v84, s47, v84
    ds_max_u32 v84, v88
    v_add_u32 v89, v92, v37
    v_sub_u32 v89, v89, v85
    v_add_u32 v92, 0x4000, v92
    v_subrev_u32 v85, s40, v85
    v_med3_i32 v85, v85, 0, s44
    v_add_u32 v85, s47, v85
    ds_max_u32 v85, v89
    v_add_u32 v90, v92, v38
    v_sub_u32 v90, v90, v86
    v_add_u32 v92, 0x4000, v92
    v_subrev_u32 v86, s40, v86
    v_med3_i32 v86, v86, 0, s44
    v_add_u32 v86, s47, v86
    ds_max_u32 v86, v90
    v_add_u32 v91, v92, v39
    v_sub_u32 v91, v91, v87
    v_subrev_u32 v87, s40, v87
    v_med3_i32 v87, v87, 0, s44
    v_add_u32 v87, s47, v87
    ds_max_u32 v87, v91
    ds_read_b128 v[40:43], v20
    ds_read_b128 v[44:47], v20 offset:16
    v_lshl_add_u32 v92, v28, 5, s40
    s_mov_b32 s45, 0x3fc004
    s_waitcnt lgkmcnt(0)
    v_max_u32 v41, v41, v40
    v_max_u32 v42, v42, v41
    v_max_u32 v43, v43, v42
    v_max_u32 v44, v44, v43
    v_max_u32 v45, v45, v44
    v_max_u32 v46, v46, v45
    v_max_u32 v47, v47, v46
    v_mov_b32 v93, v47
    v_mov_b32 v81, 0
    s_nop 1
    v_max_u32_dpp v93, v93, v93 row_shr:1 row_mask:0xf bank_mask:0xf
    s_nop 1
    v_max_u32_dpp v93, v93, v93 row_shr:2 row_mask:0xf bank_mask:0xf
    s_nop 1
    v_max_u32_dpp v93, v93, v93 row_shr:4 row_mask:0xf bank_mask:0xf
    s_nop 1
    v_max_u32_dpp v93, v93, v93 row_shr:8 row_mask:0xf bank_mask:0xf
    s_nop 1
    v_max_u32_dpp v93, v93, v93 row_bcast:15 row_mask:0xa bank_mask:0xf
    s_nop 1
    v_max_u32_dpp v93, v93, v93 row_bcast:31 row_mask:0xc bank_mask:0xf
    s_nop 1
    v_mov_b32_dpp v81, v93 wave_shr:1 row_mask:0xf bank_mask:0xf
    v_max_u32 v40, v40, v81
    v_add3_u32 v40, v40, v92, 0
    v_min_u32 v40, s45, v40
    v_lshrrev_b32 v32, 14, v40
    v_and_b32 v40, 0x3fff, v40
    v_max_u32 v41, v41, v81
    v_add3_u32 v41, v41, v92, 4
    v_min_u32 v41, s45, v41
    v_lshrrev_b32 v33, 14, v41
    v_and_b32 v41, 0x3fff, v41
    v_max_u32 v42, v42, v81
    v_add3_u32 v42, v42, v92, 8
    v_min_u32 v42, s45, v42
    v_lshrrev_b32 v34, 14, v42
    v_and_b32 v42, 0x3fff, v42
    v_max_u32 v43, v43, v81
    v_add3_u32 v43, v43, v92, 12
    v_min_u32 v43, s45, v43
    v_lshrrev_b32 v35, 14, v43
    v_and_b32 v43, 0x3fff, v43
    v_max_u32 v44, v44, v81
    v_add3_u32 v44, v44, v92, 16
    v_min_u32 v44, s45, v44
    v_lshrrev_b32 v36, 14, v44
    v_and_b32 v44, 0x3fff, v44
    v_max_u32 v45, v45, v81
    v_add3_u32 v45, v45, v92, 20
    v_min_u32 v45, s45, v45
    v_lshrrev_b32 v37, 14, v45
    v_and_b32 v45, 0x3fff, v45
    v_max_u32 v46, v46, v81
    v_add3_u32 v46, v46, v92, 24
    v_min_u32 v46, s45, v46
    v_lshrrev_b32 v38, 14, v46
    v_and_b32 v46, 0x3fff, v46
    v_max_u32 v47, v47, v81
    v_add3_u32 v47, v47, v92, 28
    v_min_u32 v47, s45, v47
    v_lshrrev_b32 v39, 14, v47
    v_and_b32 v47, 0x3fff, v47
    s_movk_i32 s44, 12800
    s_mov_b32 s45, 0xcfff40
    s_mov_b32 s60, 102400
    s_mov_b32 s61, 65535
    v_lshl_add_u32 v31, v32, 14, s54
    v_and_b32 v30, 192, v40
    v_mad_u32_u24 v31, v30, s61, v31
    v_mad_u32_u24 v30, v32, s44, v40
    v_cmp_gt_u32 vcc, 192, v40
    v_add_u32 v31, v31, v40
    v_add_u32 v30, s45, v30
    v_cndmask_b32 v80, v30, v31, vcc
    buffer_load_dword v48, v80, s[20:23], 0 offen sc1
    v_mul_u32_u24 v64, s60, v32
    v_lshl_add_u32 v31, v33, 14, s54
    v_and_b32 v30, 192, v41
    v_mad_u32_u24 v31, v30, s61, v31
    v_mad_u32_u24 v30, v33, s44, v41
    v_cmp_gt_u32 vcc, 192, v41
    v_add_u32 v31, v31, v41
    v_add_u32 v30, s45, v30
    v_cndmask_b32 v81, v30, v31, vcc
    buffer_load_dword v49, v81, s[20:23], 0 offen sc1
    v_mul_u32_u24 v65, s60, v33
    v_lshl_add_u32 v31, v34, 14, s54
    v_and_b32 v30, 192, v42
    v_mad_u32_u24 v31, v30, s61, v31
    v_mad_u32_u24 v30, v34, s44, v42
    v_cmp_gt_u32 vcc, 192, v42
    v_add_u32 v31, v31, v42
    v_add_u32 v30, s45, v30
    v_cndmask_b32 v82, v30, v31, vcc
    buffer_load_dword v50, v82, s[20:23], 0 offen sc1
    v_mul_u32_u24 v66, s60, v34
    v_lshl_add_u32 v31, v35, 14, s54
    v_and_b32 v30, 192, v43
    v_mad_u32_u24 v31, v30, s61, v31
    v_mad_u32_u24 v30, v35, s44, v43
    v_cmp_gt_u32 vcc, 192, v43
    v_add_u32 v31, v31, v43
    v_add_u32 v30, s45, v30
    v_cndmask_b32 v83, v30, v31, vcc
    buffer_load_dword v51, v83, s[20:23], 0 offen sc1
    v_mul_u32_u24 v67, s60, v35
    v_lshl_add_u32 v31, v36, 14, s54
    v_and_b32 v30, 192, v44
    v_mad_u32_u24 v31, v30, s61, v31
    v_mad_u32_u24 v30, v36, s44, v44
    v_cmp_gt_u32 vcc, 192, v44
    v_add_u32 v31, v31, v44
    v_add_u32 v30, s45, v30
    v_cndmask_b32 v84, v30, v31, vcc
    buffer_load_dword v52, v84, s[20:23], 0 offen sc1
    v_mul_u32_u24 v68, s60, v36
    v_lshl_add_u32 v31, v37, 14, s54
    v_and_b32 v30, 192, v45
    v_mad_u32_u24 v31, v30, s61, v31
    v_mad_u32_u24 v30, v37, s44, v45
    v_cmp_gt_u32 vcc, 192, v45
    v_add_u32 v31, v31, v45
    v_add_u32 v30, s45, v30
    v_cndmask_b32 v85, v30, v31, vcc
    buffer_load_dword v53, v85, s[20:23], 0 offen sc1
    v_mul_u32_u24 v69, s60, v37
    v_lshl_add_u32 v31, v38, 14, s54
    v_and_b32 v30, 192, v46
    v_mad_u32_u24 v31, v30, s61, v31
    v_mad_u32_u24 v30, v38, s44, v46
    v_cmp_gt_u32 vcc, 192, v46
    v_add_u32 v31, v31, v46
    v_add_u32 v30, s45, v30
    v_cndmask_b32 v86, v30, v31, vcc
    buffer_load_dword v54, v86, s[20:23], 0 offen sc1
    v_mul_u32_u24 v70, s60, v38
    v_lshl_add_u32 v31, v39, 14, s54
    v_and_b32 v30, 192, v47
    v_mad_u32_u24 v31, v30, s61, v31
    v_mad_u32_u24 v30, v39, s44, v47
    v_cmp_gt_u32 vcc, 192, v47
    v_add_u32 v31, v31, v47
    v_add_u32 v30, s45, v30
    v_cndmask_b32 v87, v30, v31, vcc
    buffer_load_dword v55, v87, s[20:23], 0 offen sc1
    v_mul_u32_u24 v71, s60, v39
    s_waitcnt vmcnt(0)
    s_cmp_eq_u32 s56, 0
    s_cbranch_scc1 M_DECODE
    s_add_u32 s44, s3, s37
    s_lshl_b32 s45, s44, 13
    s_add_u32 s45, s45, 670
    s_mul_hi_u32 s38, s45, s46
    s_lshr_b32 s38, s38, 9
    s_add_u32 s44, s44, 1
    s_lshl_b32 s45, s44, 13
    s_add_u32 s45, s45, 670
    s_mul_hi_u32 s39, s45, s46
    s_lshr_b32 s39, s39, 9
    s_min_u32 s39, s39, 25000
    s_mov_b32 s56, 0
    s_sub_u32 s42, s41, s40
    s_min_u32 s42, s42, 2048
    s_sub_u32 s62, s42, 4
    s_or_b32 s62, s62, s31
    s_bitcmp0_b32 s62, 6
    s_cselect_b32 s62, 1, 0
    s_add_u32 s42, s42, 127
    s_lshr_b32 s42, s42, 7
    s_branch M_LST
M_DECODE:
    v_lshlrev_b32_sdwa v80, 6, v48 dst_sel:DWORD dst_unused:UNUSED_PAD src0_sel:DWORD src1_sel:WORD_0
    v_lshlrev_b32_sdwa v81, 6, v49 dst_sel:DWORD dst_unused:UNUSED_PAD src0_sel:DWORD src1_sel:WORD_0
    v_lshlrev_b32_sdwa v82, 6, v50 dst_sel:DWORD dst_unused:UNUSED_PAD src0_sel:DWORD src1_sel:WORD_0
    v_lshlrev_b32_sdwa v83, 6, v51 dst_sel:DWORD dst_unused:UNUSED_PAD src0_sel:DWORD src1_sel:WORD_0
    ds_write_b128 v20, v[80:83] offset:0
    v_lshlrev_b32_sdwa v84, 6, v52 dst_sel:DWORD dst_unused:UNUSED_PAD src0_sel:DWORD src1_sel:WORD_0
    v_lshlrev_b32_sdwa v85, 6, v53 dst_sel:DWORD dst_unused:UNUSED_PAD src0_sel:DWORD src1_sel:WORD_0
    v_lshlrev_b32_sdwa v86, 6, v54 dst_sel:DWORD dst_unused:UNUSED_PAD src0_sel:DWORD src1_sel:WORD_0
    v_lshlrev_b32_sdwa v87, 6, v55 dst_sel:DWORD dst_unused:UNUSED_PAD src0_sel:DWORD src1_sel:WORD_0
    ds_write_b128 v20, v[84:87] offset:16
    v_bfe_u32 v88, v48, 16, 12
    v_lshl_add_u32 v88, v88, 5, v64
    v_bfe_u32 v89, v49, 16, 12
    v_lshl_add_u32 v89, v89, 5, v65
    v_bfe_u32 v90, v50, 16, 12
    v_lshl_add_u32 v90, v90, 5, v66
    v_bfe_u32 v91, v51, 16, 12
    v_lshl_add_u32 v91, v91, 5, v67
    ds_write_b128 v20, v[88:91] offset:2048
    v_bfe_u32 v92, v52, 16, 12
    v_lshl_add_u32 v92, v92, 5, v68
    v_bfe_u32 v93, v53, 16, 12
    v_lshl_add_u32 v93, v93, 5, v69
    v_bfe_u32 v94, v54, 16, 12
    v_lshl_add_u32 v94, v94, 5, v70
    v_bfe_u32 v95, v55, 16, 12
    v_lshl_add_u32 v95, v95, 5, v71
    ds_write_b128 v20, v[92:95] offset:2064
    s_mov_b32 s44, 0x04070003
    v_perm_b32 v32, v49, v48, s44
    v_and_b32 v32, 0x01f001f0, v32
    v_perm_b32 v33, v51, v50, s44
    v_and_b32 v33, 0x01f001f0, v33
    v_perm_b32 v34, v53, v52, s44
    v_and_b32 v34, 0x01f001f0, v34
    v_perm_b32 v35, v55, v54, s44
    v_and_b32 v35, 0x01f001f0, v35
    ds_write_b128 v21, v[32:35] offset:4096
    s_sub_u32 s42, s41, s40
    s_min_u32 s42, s42, 2048
    s_sub_u32 s62, s42, 4
    s_or_b32 s62, s62, s31
    s_bitcmp0_b32 s62, 6
    s_cselect_b32 s62, 1, 0
    s_add_u32 s42, s42, 127
    s_lshr_b32 s42, s42, 7
    v_lshl_add_u32 v31, v28, 4, s47
    ds_read_b128 v[116:119], v31 offset:4096
    v_and_b32 v31, 3, v28
    v_lshl_add_u32 v31, v31, 2, s48
    v_mov_b32 v30, 1
    ds_read_b128 v[16:19], v6 offset:0
    ds_read_b32 v11, v7 offset:0
    s_waitcnt lgkmcnt(0)
    v_add_u32 v16, v16, v2
    v_xad_u32 v17, v2, 64, v17
    v_add_u32 v18, v18, v2
    v_xad_u32 v19, v2, 64, v19
    v_add_u32 v11, v11, v3
    v_add_u32_sdwa v120, v31, v116 dst_sel:DWORD dst_unused:UNUSED_PAD src0_sel:DWORD src1_sel:WORD_0
    ds_add_u32 v120, v30
    v_add_u32_sdwa v121, v31, v116 dst_sel:DWORD dst_unused:UNUSED_PAD src0_sel:DWORD src1_sel:WORD_1
    ds_add_u32 v121, v30
    v_add_u32_sdwa v122, v31, v117 dst_sel:DWORD dst_unused:UNUSED_PAD src0_sel:DWORD src1_sel:WORD_0
    ds_add_u32 v122, v30
    v_add_u32_sdwa v123, v31, v117 dst_sel:DWORD dst_unused:UNUSED_PAD src0_sel:DWORD src1_sel:WORD_1
    ds_add_u32 v123, v30
    v_add_u32_sdwa v124, v31, v118 dst_sel:DWORD dst_unused:UNUSED_PAD src0_sel:DWORD src1_sel:WORD_0
    ds_add_u32 v124, v30
    v_add_u32_sdwa v125, v31, v118 dst_sel:DWORD dst_unused:UNUSED_PAD src0_sel:DWORD src1_sel:WORD_1
    ds_add_u32 v125, v30
    v_add_u32_sdwa v126, v31, v119 dst_sel:DWORD dst_unused:UNUSED_PAD src0_sel:DWORD src1_sel:WORD_0
    ds_add_u32 v126, v30
    v_add_u32_sdwa v127, v31, v119 dst_sel:DWORD dst_unused:UNUSED_PAD src0_sel:DWORD src1_sel:WORD_1
    ds_add_u32 v127, v30
    s_add_u32 m0, s43, 0
    s_nop 0
    buffer_load_dwordx4 v16, s[12:15], 0 offen lds
    s_add_u32 m0, s43, 1024
    s_nop 0
    buffer_load_dwordx4 v17, s[12:15], 0 offen lds
    s_add_u32 m0, s43, 2048
    s_nop 0
    buffer_load_dwordx4 v18, s[12:15], 0 offen lds
    s_add_u32 m0, s43, 3072
    s_nop 0
    buffer_load_dwordx4 v19, s[12:15], 0 offen lds
    s_add_u32 m0, s43, 4096
    s_nop 0
    buffer_load_dwordx4 v11, s[16:19], 0 offen lds
    s_cmp_eq_u32 s42, 0
    s_cbranch_scc1 M_EPI0
    ds_read_b128 v[16:19], v6 offset:128
    ds_read_b32 v11, v7 offset:128
    s_waitcnt lgkmcnt(0)
    v_add_u32 v16, v16, v2
    v_xad_u32 v17, v2, 64, v17
    v_add_u32 v18, v18, v2
    v_xad_u32 v19, v2, 64, v19
    v_add_u32 v11, v11, v3
    s_add_u32 m0, s43, 40960
    s_nop 0
    buffer_load_dwordx4 v16, s[12:15], 0 offen lds
    s_add_u32 m0, s43, 41984
    s_nop 0
    buffer_load_dwordx4 v17, s[12:15], 0 offen lds
    s_add_u32 m0, s43, 43008
    s_nop 0
    buffer_load_dwordx4 v18, s[12:15], 0 offen lds
    s_add_u32 m0, s43, 44032
    s_nop 0
    buffer_load_dwordx4 v19, s[12:15], 0 offen lds
    s_add_u32 m0, s43, 45056
    s_nop 0
    buffer_load_dwordx4 v11, s[16:19], 0 offen lds
    ds_read_u16 v12, v9 offset:0
    ds_read_u16 v13, v9 offset:4
    ds_read_b32 v14, v8 offset:0
    v_mov_b32 v32, 0
    v_mov_b32 v33, 0
    v_mov_b32 v34, 0
    v_mov_b32 v35, 0
    v_mov_b32 v36, 0
    v_mov_b32 v37, 0
    v_mov_b32 v38, 0
    v_mov_b32 v39, 0
    v_mov_b32 v40, 0
    v_mov_b32 v41, 0
    v_mov_b32 v42, 0
    v_mov_b32 v43, 0
    v_mov_b32 v44, 0
    v_mov_b32 v45, 0
    v_mov_b32 v46, 0
    v_mov_b32 v47, 0
    v_mov_b32 v20, 0
    v_mov_b32 v72, 0
    v_mov_b32 v21, 0
    v_mov_b32 v73, 0
    v_mov_b32 v22, 0
    v_mov_b32 v74, 0
    v_mov_b32 v23, 0
    v_mov_b32 v75, 0
    ds_read_b128 v[16:19], v6 offset:256
    ds_read_b32 v11, v7 offset:256
    s_waitcnt lgkmcnt(0)
    v_add_u32 v16, v16, v2
    v_xad_u32 v17, v2, 64, v17
    v_add_u32 v18, v18, v2
    v_xad_u32 v19, v2, 64, v19
    v_add_u32 v11, v11, v3
    v_xad_u32 v12, v12, v29, v5
    v_xad_u32 v13, v13, v29, v5
    v_xor_b32_sdwa v15, v4, v14 dst_sel:DWORD dst_unused:UNUSED_PAD src0_sel:DWORD src1_sel:WORD_1
    v_xor_b32_sdwa v14, v4, v14 dst_sel:DWORD dst_unused:UNUSED_PAD src0_sel:DWORD src1_sel:WORD_0
    s_waitcnt vmcnt(5)
    ds_read_b128 v[56:59], v0 offset:0
    ds_read_b128 v[60:63], v0 offset:2048
    ds_read_b128 v[64:67], v1 offset:0
    ds_read_b128 v[68:71], v1 offset:2048
    ds_read_b128 v[48:51], v12
    ds_read_b128 v[52:55], v13
    s_waitcnt lgkmcnt(0)
    s_add_u32 m0, s43, 0
    s_nop 0
    buffer_load_dwordx4 v16, s[12:15], 0 offen lds
    s_add_u32 m0, s43, 1024
    s_nop 0
    buffer_load_dwordx4 v17, s[12:15], 0 offen lds
    s_add_u32 m0, s43, 2048
    s_nop 0
    buffer_load_dwordx4 v18, s[12:15], 0 offen lds
    s_add_u32 m0, s43, 3072
    s_nop 0
    buffer_load_dwordx4 v19, s[12:15], 0 offen lds
    s_add_u32 m0, s43, 4096
    s_nop 0
    buffer_load_dwordx4 v11, s[16:19], 0 offen lds
    v_mfma_f32_16x16x32_bf16 v[96:99], v[56:59], v[160:163], 0
    v_mfma_f32_16x16x32_bf16 v[104:107], v[56:59], v[164:167], 0
    v_mfma_f32_16x16x32_bf16 v[100:103], v[60:63], v[160:163], 0
    v_mfma_f32_16x16x32_bf16 v[108:111], v[60:63], v[164:167], 0
    v_mfma_f32_16x16x32_bf16 v[96:99], v[64:67], v[192:195], v[96:99]
    v_mfma_f32_16x16x32_bf16 v[104:107], v[64:67], v[196:199], v[104:107]
    v_mfma_f32_16x16x32_bf16 v[100:103], v[68:71], v[192:195], v[100:103]
    v_mfma_f32_16x16x32_bf16 v[108:111], v[68:71], v[196:199], v[108:111]
    v_mfma_f32_16x16x32_bf16 v[96:99], v[48:51], v[224:227], v[96:99]
    v_mfma_f32_16x16x32_bf16 v[104:107], v[48:51], v[228:231], v[104:107]
    v_mfma_f32_16x16x32_bf16 v[100:103], v[52:55], v[224:227], v[100:103]
    v_mfma_f32_16x16x32_bf16 v[108:111], v[52:55], v[228:231], v[108:111]
    s_nop 7
    s_cmp_lg_u32 s57, 0
    s_cbranch_scc1 M_SLOOP
    s_setprio 1
    s_branch M_LOOP
M_SLOOP:
    v_exp_f32 v80, v96
    v_exp_f32 v81, v97
    v_smfmac_f32_16x16x64_bf16 v[152:155], v[20:23], v[32:39], v10 abid:1
    v_exp_f32 v82, v98
    v_exp_f32 v83, v99
    v_smfmac_f32_16x16x64_bf16 v[156:159], v[20:23], v[40:47], v10 abid:1
    v_exp_f32 v84, v100
    v_exp_f32 v85, v101
    ds_read_b64_tr_b16 v[20:21], v14
    v_mfma_f32_16x16x32_bf16 v[112:115], v[56:59], v[168:171], 0
    v_exp_f32 v86, v102
    ds_read_b64_tr_b16 v[22:23], v15
    v_exp_f32 v87, v103
    v_mfma_f32_16x16x32_bf16 v[120:123], v[56:59], v[172:175], 0
    v_exp_f32 v88, v104
    v_exp_f32 v89, v105
    v_mfma_f32_16x16x32_bf16 v[116:119], v[60:63], v[168:171], 0
    v_exp_f32 v90, v106
    v_exp_f32 v91, v107
    v_mfma_f32_16x16x32_bf16 v[124:127], v[60:63], v[172:175], 0
    v_exp_f32 v92, v108
    v_exp_f32 v93, v109
    v_mfma_f32_16x16x32_bf16 v[112:115], v[64:67], v[200:203], v[112:115]
    v_exp_f32 v94, v110
    v_exp_f32 v95, v111
    v_add_f32 v80, 1.0, v80
    v_add_f32 v81, 1.0, v81
    v_add_f32 v82, 1.0, v82
    v_add_f32 v83, 1.0, v83
    v_add_f32 v84, 1.0, v84
    v_add_f32 v85, 1.0, v85
    v_add_f32 v86, 1.0, v86
    v_add_f32 v87, 1.0, v87
    v_add_f32 v88, 1.0, v88
    v_add_f32 v89, 1.0, v89
    v_add_f32 v90, 1.0, v90
    v_add_f32 v91, 1.0, v91
    v_add_f32 v92, 1.0, v92
    v_add_f32 v93, 1.0, v93
    v_add_f32 v94, 1.0, v94
    v_add_f32 v95, 1.0, v95
    v_mfma_f32_16x16x32_bf16 v[120:123], v[64:67], v[204:207], v[120:123]
    v_rcp_f32 v80, v80
    v_rcp_f32 v81, v81
    v_mfma_f32_16x16x32_bf16 v[116:119], v[68:71], v[200:203], v[116:119]
    v_rcp_f32 v82, v82
    v_rcp_f32 v83, v83
    v_mfma_f32_16x16x32_bf16 v[124:127], v[68:71], v[204:207], v[124:127]
    v_rcp_f32 v84, v84
    v_rcp_f32 v85, v85
    v_mfma_f32_16x16x32_bf16 v[112:115], v[48:51], v[232:235], v[112:115]
    v_rcp_f32 v86, v86
    v_rcp_f32 v87, v87
    v_mfma_f32_16x16x32_bf16 v[120:123], v[48:51], v[236:239], v[120:123]
    v_rcp_f32 v88, v88
    v_rcp_f32 v89, v89
    v_mfma_f32_16x16x32_bf16 v[116:119], v[52:55], v[232:235], v[116:119]
    v_rcp_f32 v90, v90
    v_rcp_f32 v91, v91
    v_mfma_f32_16x16x32_bf16 v[124:127], v[52:55], v[236:239], v[124:127]
    v_rcp_f32 v92, v92
    v_rcp_f32 v93, v93
    v_rcp_f32 v94, v94
    v_rcp_f32 v95, v95
    v_mul_f32 v32, v80, v96
    v_mul_f32 v33, v81, v97
    v_mul_f32 v34, v82, v98
    v_mul_f32 v35, v83, v99
    v_mul_f32 v36, v84, v100
    v_mul_f32 v37, v85, v101
    v_mul_f32 v38, v86, v102
    v_mul_f32 v39, v87, v103
    v_mul_f32 v40, v88, v104
    v_mul_f32 v41, v89, v105
    v_mul_f32 v42, v90, v106
    v_mul_f32 v43, v91, v107
    v_mul_f32 v44, v92, v108
    v_mul_f32 v45, v93, v109
    v_mul_f32 v46, v94, v110
    v_mul_f32 v47, v95, v111
    s_waitcnt lgkmcnt(0)
    v_exp_f32 v80, v112
    v_exp_f32 v81, v113
    v_smfmac_f32_16x16x64_bf16 v[128:131], v[20:23], v[32:39], v10 abid:1
    v_exp_f32 v82, v114
    v_exp_f32 v83, v115
    v_smfmac_f32_16x16x64_bf16 v[132:135], v[20:23], v[40:47], v10 abid:1
    v_exp_f32 v84, v116
    ds_read_b32 v14, v8 offset:64
    v_exp_f32 v85, v117
    ds_read_u16 v12, v9 offset:64
    ds_read_u16 v13, v9 offset:68
    v_mfma_f32_16x16x32_bf16 v[96:99], v[56:59], v[176:179], 0
    v_exp_f32 v86, v118
    v_exp_f32 v87, v119
    v_mfma_f32_16x16x32_bf16 v[104:107], v[56:59], v[180:183], 0
    v_exp_f32 v88, v120
    v_exp_f32 v89, v121
    v_mfma_f32_16x16x32_bf16 v[100:103], v[60:63], v[176:179], 0
    v_exp_f32 v90, v122
    v_exp_f32 v91, v123
    v_mfma_f32_16x16x32_bf16 v[108:111], v[60:63], v[180:183], 0
    v_exp_f32 v92, v124
    v_exp_f32 v93, v125
    v_mfma_f32_16x16x32_bf16 v[96:99], v[64:67], v[208:211], v[96:99]
    v_exp_f32 v94, v126
    v_exp_f32 v95, v127
    v_add_f32 v80, 1.0, v80
    v_add_f32 v81, 1.0, v81
    v_add_f32 v82, 1.0, v82
    v_add_f32 v83, 1.0, v83
    v_add_f32 v84, 1.0, v84
    v_add_f32 v85, 1.0, v85
    v_add_f32 v86, 1.0, v86
    v_add_f32 v87, 1.0, v87
    v_add_f32 v88, 1.0, v88
    v_add_f32 v89, 1.0, v89
    v_add_f32 v90, 1.0, v90
    v_add_f32 v91, 1.0, v91
    v_add_f32 v92, 1.0, v92
    v_add_f32 v93, 1.0, v93
    v_add_f32 v94, 1.0, v94
    v_add_f32 v95, 1.0, v95
    v_mfma_f32_16x16x32_bf16 v[104:107], v[64:67], v[212:215], v[104:107]
    v_rcp_f32 v80, v80
    v_rcp_f32 v81, v81
    v_mfma_f32_16x16x32_bf16 v[100:103], v[68:71], v[208:211], v[100:103]
    v_rcp_f32 v82, v82
    v_rcp_f32 v83, v83
    v_mfma_f32_16x16x32_bf16 v[108:111], v[68:71], v[212:215], v[108:111]
    v_rcp_f32 v84, v84
    v_rcp_f32 v85, v85
    v_mfma_f32_16x16x32_bf16 v[96:99], v[48:51], v[240:243], v[96:99]
    v_rcp_f32 v86, v86
    v_rcp_f32 v87, v87
    v_mfma_f32_16x16x32_bf16 v[104:107], v[48:51], v[244:247], v[104:107]
    v_rcp_f32 v88, v88
    v_rcp_f32 v89, v89
    v_mfma_f32_16x16x32_bf16 v[100:103], v[52:55], v[240:243], v[100:103]
    v_rcp_f32 v90, v90
    v_rcp_f32 v91, v91
    v_mfma_f32_16x16x32_bf16 v[108:111], v[52:55], v[244:247], v[108:111]
    v_rcp_f32 v92, v92
    v_rcp_f32 v93, v93
    v_rcp_f32 v94, v94
    v_rcp_f32 v95, v95
    s_waitcnt lgkmcnt(0)
    v_mul_f32 v32, v80, v112
    v_mul_f32 v33, v81, v113
    v_mul_f32 v34, v82, v114
    v_mul_f32 v35, v83, v115
    v_mul_f32 v36, v84, v116
    v_mul_f32 v37, v85, v117
    v_mul_f32 v38, v86, v118
    v_mul_f32 v39, v87, v119
    v_xor_b32_sdwa v15, v4, v14 dst_sel:DWORD dst_unused:UNUSED_PAD src0_sel:DWORD src1_sel:WORD_1
    v_xor_b32_sdwa v14, v4, v14 dst_sel:DWORD dst_unused:UNUSED_PAD src0_sel:DWORD src1_sel:WORD_0
    v_xad_u32 v12, v12, v29, v5
    v_xad_u32 v13, v13, v29, v5
    v_mul_f32 v40, v88, v120
    v_mul_f32 v41, v89, v121
    v_mul_f32 v42, v90, v122
    v_mul_f32 v43, v91, v123
    v_mul_f32 v44, v92, v124
    v_mul_f32 v45, v93, v125
    v_mul_f32 v46, v94, v126
    v_mul_f32 v47, v95, v127
    v_exp_f32 v80, v96
    v_exp_f32 v81, v97
    ds_read_b128 v[16:19], v6 offset:384
    v_smfmac_f32_16x16x64_bf16 v[136:139], v[20:23], v[32:39], v10 abid:1
    v_exp_f32 v82, v98
    ds_read_b32 v11, v7 offset:384
    v_exp_f32 v83, v99
    v_smfmac_f32_16x16x64_bf16 v[140:143], v[20:23], v[40:47], v10 abid:1
    v_exp_f32 v84, v100
    v_exp_f32 v85, v101
    s_waitcnt vmcnt(5)
    v_mfma_f32_16x16x32_bf16 v[112:115], v[56:59], v[184:187], 0
    v_exp_f32 v86, v102
    v_exp_f32 v87, v103
    v_mfma_f32_16x16x32_bf16 v[120:123], v[56:59], v[188:191], 0
    v_exp_f32 v88, v104
    ds_read_b128 v[56:59], v0 offset:40960
    v_exp_f32 v89, v105
    v_mfma_f32_16x16x32_bf16 v[116:119], v[60:63], v[184:187], 0
    v_exp_f32 v90, v106
    v_exp_f32 v91, v107
    v_mfma_f32_16x16x32_bf16 v[124:127], v[60:63], v[188:191], 0
    v_exp_f32 v92, v108
    ds_read_b128 v[60:63], v0 offset:43008
    v_exp_f32 v93, v109
    v_mfma_f32_16x16x32_bf16 v[112:115], v[64:67], v[216:219], v[112:115]
    v_exp_f32 v94, v110
    v_exp_f32 v95, v111
    v_add_f32 v80, 1.0, v80
    v_add_f32 v81, 1.0, v81
    v_add_f32 v82, 1.0, v82
    v_add_f32 v83, 1.0, v83
    v_add_f32 v84, 1.0, v84
    v_add_f32 v85, 1.0, v85
    v_add_f32 v86, 1.0, v86
    v_add_f32 v87, 1.0, v87
    v_add_f32 v88, 1.0, v88
    v_add_f32 v89, 1.0, v89
    v_add_f32 v90, 1.0, v90
    v_add_f32 v91, 1.0, v91
    v_add_f32 v92, 1.0, v92
    v_add_f32 v93, 1.0, v93
    v_add_f32 v94, 1.0, v94
    v_add_f32 v95, 1.0, v95
    v_mfma_f32_16x16x32_bf16 v[120:123], v[64:67], v[220:223], v[120:123]
    v_rcp_f32 v80, v80
    ds_read_b128 v[64:67], v1 offset:40960
    v_rcp_f32 v81, v81
    v_mfma_f32_16x16x32_bf16 v[116:119], v[68:71], v[216:219], v[116:119]
    v_rcp_f32 v82, v82
    v_rcp_f32 v83, v83
    v_mfma_f32_16x16x32_bf16 v[124:127], v[68:71], v[220:223], v[124:127]
    v_rcp_f32 v84, v84
    ds_read_b128 v[68:71], v1 offset:43008
    v_rcp_f32 v85, v85
    v_mfma_f32_16x16x32_bf16 v[112:115], v[48:51], v[248:251], v[112:115]
    v_rcp_f32 v86, v86
    v_rcp_f32 v87, v87
    v_mfma_f32_16x16x32_bf16 v[120:123], v[48:51], v[252:255], v[120:123]
    v_rcp_f32 v88, v88
    ds_read_b128 v[48:51], v12
    v_rcp_f32 v89, v89
    v_mfma_f32_16x16x32_bf16 v[116:119], v[52:55], v[248:251], v[116:119]
    v_rcp_f32 v90, v90
    v_rcp_f32 v91, v91
    v_mfma_f32_16x16x32_bf16 v[124:127], v[52:55], v[252:255], v[124:127]
    v_rcp_f32 v92, v92
    ds_read_b128 v[52:55], v13
    v_rcp_f32 v93, v93
    v_rcp_f32 v94, v94
    v_rcp_f32 v95, v95
    v_mul_f32 v32, v80, v96
    v_mul_f32 v33, v81, v97
    v_mul_f32 v34, v82, v98
    v_mul_f32 v35, v83, v99
    v_mul_f32 v36, v84, v100
    v_mul_f32 v37, v85, v101
    v_mul_f32 v38, v86, v102
    v_mul_f32 v39, v87, v103
    v_mul_f32 v40, v88, v104
    v_mul_f32 v41, v89, v105
    v_mul_f32 v42, v90, v106
    v_mul_f32 v43, v91, v107
    v_mul_f32 v44, v92, v108
    v_mul_f32 v45, v93, v109
    v_mul_f32 v46, v94, v110
    v_mul_f32 v47, v95, v111
    v_exp_f32 v80, v112
    v_exp_f32 v81, v113
    v_smfmac_f32_16x16x64_bf16 v[144:147], v[20:23], v[32:39], v10 abid:1
    v_exp_f32 v82, v114
    v_exp_f32 v83, v115
    v_smfmac_f32_16x16x64_bf16 v[148:151], v[20:23], v[40:47], v10 abid:1
    v_exp_f32 v84, v116
    v_exp_f32 v85, v117
    s_waitcnt lgkmcnt(0)
    v_mfma_f32_16x16x32_bf16 v[96:99], v[56:59], v[160:163], 0
    v_exp_f32 v86, v118
    v_exp_f32 v87, v119
    v_mfma_f32_16x16x32_bf16 v[104:107], v[56:59], v[164:167], 0
    v_exp_f32 v88, v120
    v_exp_f32 v89, v121
    v_mfma_f32_16x16x32_bf16 v[100:103], v[60:63], v[160:163], 0
    v_exp_f32 v90, v122
    v_exp_f32 v91, v123
    v_mfma_f32_16x16x32_bf16 v[108:111], v[60:63], v[164:167], 0
    v_exp_f32 v92, v124
    v_exp_f32 v93, v125
    v_mfma_f32_16x16x32_bf16 v[96:99], v[64:67], v[192:195], v[96:99]
    v_exp_f32 v94, v126
    v_exp_f32 v95, v127
    v_add_f32 v80, 1.0, v80
    v_add_f32 v81, 1.0, v81
    v_add_f32 v82, 1.0, v82
    v_add_f32 v83, 1.0, v83
    v_add_f32 v84, 1.0, v84
    v_add_f32 v85, 1.0, v85
    v_add_f32 v86, 1.0, v86
    v_add_f32 v87, 1.0, v87
    v_add_f32 v88, 1.0, v88
    v_add_f32 v89, 1.0, v89
    v_add_f32 v90, 1.0, v90
    v_add_f32 v91, 1.0, v91
    v_add_f32 v92, 1.0, v92
    v_add_f32 v93, 1.0, v93
    v_add_f32 v94, 1.0, v94
    v_add_f32 v95, 1.0, v95
    v_add_u32 v16, v16, v2
    v_xad_u32 v17, v2, 64, v17
    v_add_u32 v18, v18, v2
    v_xad_u32 v19, v2, 64, v19
    v_add_u32 v11, v11, v3
    v_mfma_f32_16x16x32_bf16 v[104:107], v[64:67], v[196:199], v[104:107]
    v_rcp_f32 v80, v80
    s_add_u32 m0, s43, 40960
    v_rcp_f32 v81, v81
    buffer_load_dwordx4 v16, s[12:15], 0 offen lds
    v_mfma_f32_16x16x32_bf16 v[100:103], v[68:71], v[192:195], v[100:103]
    v_rcp_f32 v82, v82
    s_add_u32 m0, s43, 41984
    v_rcp_f32 v83, v83
    buffer_load_dwordx4 v17, s[12:15], 0 offen lds
    v_mfma_f32_16x16x32_bf16 v[108:111], v[68:71], v[196:199], v[108:111]
    v_rcp_f32 v84, v84
    s_add_u32 m0, s43, 43008
    v_rcp_f32 v85, v85
    buffer_load_dwordx4 v18, s[12:15], 0 offen lds
    v_mfma_f32_16x16x32_bf16 v[96:99], v[48:51], v[224:227], v[96:99]
    v_rcp_f32 v86, v86
    s_add_u32 m0, s43, 44032
    v_rcp_f32 v87, v87
    buffer_load_dwordx4 v19, s[12:15], 0 offen lds
    v_mfma_f32_16x16x32_bf16 v[104:107], v[48:51], v[228:231], v[104:107]
    v_rcp_f32 v88, v88
    s_add_u32 m0, s43, 45056
    v_rcp_f32 v89, v89
    buffer_load_dwordx4 v11, s[16:19], 0 offen lds
    v_mfma_f32_16x16x32_bf16 v[100:103], v[52:55], v[224:227], v[100:103]
    v_rcp_f32 v90, v90
    v_rcp_f32 v91, v91
    v_mfma_f32_16x16x32_bf16 v[108:111], v[52:55], v[228:231], v[108:111]
    v_rcp_f32 v92, v92
    s_sub_u32 s42, s42, 1
    v_rcp_f32 v93, v93
    s_cmp_eq_u32 s42, 0
    v_rcp_f32 v94, v94
    v_rcp_f32 v95, v95
    v_mul_f32 v32, v80, v112
    v_mul_f32 v33, v81, v113
    v_mul_f32 v34, v82, v114
    v_mul_f32 v35, v83, v115
    v_mul_f32 v36, v84, v116
    v_mul_f32 v37, v85, v117
    v_mul_f32 v38, v86, v118
    v_mul_f32 v39, v87, v119
    v_mul_f32 v40, v88, v120
    v_mul_f32 v41, v89, v121
    v_mul_f32 v42, v90, v122
    v_mul_f32 v43, v91, v123
    v_mul_f32 v44, v92, v124
    v_mul_f32 v45, v93, v125
    v_mul_f32 v46, v94, v126
    v_mul_f32 v47, v95, v127
    s_cbranch_scc1 M_RARE
    v_exp_f32 v80, v96
    v_exp_f32 v81, v97
    v_smfmac_f32_16x16x64_bf16 v[152:155], v[20:23], v[32:39], v10 abid:1
    v_exp_f32 v82, v98
    v_exp_f32 v83, v99
    v_smfmac_f32_16x16x64_bf16 v[156:159], v[20:23], v[40:47], v10 abid:1
    v_exp_f32 v84, v100
    v_exp_f32 v85, v101
    ds_read_b64_tr_b16 v[20:21], v14
    v_mfma_f32_16x16x32_bf16 v[112:115], v[56:59], v[168:171], 0
    v_exp_f32 v86, v102
    ds_read_b64_tr_b16 v[22:23], v15
    v_exp_f32 v87, v103
    v_mfma_f32_16x16x32_bf16 v[120:123], v[56:59], v[172:175], 0
    v_exp_f32 v88, v104
    v_exp_f32 v89, v105
    v_mfma_f32_16x16x32_bf16 v[116:119], v[60:63], v[168:171], 0
    v_exp_f32 v90, v106
    v_exp_f32 v91, v107
    v_mfma_f32_16x16x32_bf16 v[124:127], v[60:63], v[172:175], 0
    v_exp_f32 v92, v108
    v_exp_f32 v93, v109
    v_mfma_f32_16x16x32_bf16 v[112:115], v[64:67], v[200:203], v[112:115]
    v_exp_f32 v94, v110
    v_exp_f32 v95, v111
    v_add_f32 v80, 1.0, v80
    v_add_f32 v81, 1.0, v81
    v_add_f32 v82, 1.0, v82
    v_add_f32 v83, 1.0, v83
    v_add_f32 v84, 1.0, v84
    v_add_f32 v85, 1.0, v85
    v_add_f32 v86, 1.0, v86
    v_add_f32 v87, 1.0, v87
    v_add_f32 v88, 1.0, v88
    v_add_f32 v89, 1.0, v89
    v_add_f32 v90, 1.0, v90
    v_add_f32 v91, 1.0, v91
    v_add_f32 v92, 1.0, v92
    v_add_f32 v93, 1.0, v93
    v_add_f32 v94, 1.0, v94
    v_add_f32 v95, 1.0, v95
    v_mfma_f32_16x16x32_bf16 v[120:123], v[64:67], v[204:207], v[120:123]
    v_rcp_f32 v80, v80
    v_rcp_f32 v81, v81
    v_mfma_f32_16x16x32_bf16 v[116:119], v[68:71], v[200:203], v[116:119]
    v_rcp_f32 v82, v82
    v_rcp_f32 v83, v83
    v_mfma_f32_16x16x32_bf16 v[124:127], v[68:71], v[204:207], v[124:127]
    v_rcp_f32 v84, v84
    v_rcp_f32 v85, v85
    v_mfma_f32_16x16x32_bf16 v[112:115], v[48:51], v[232:235], v[112:115]
    v_rcp_f32 v86, v86
    v_rcp_f32 v87, v87
    v_mfma_f32_16x16x32_bf16 v[120:123], v[48:51], v[236:239], v[120:123]
    v_rcp_f32 v88, v88
    v_rcp_f32 v89, v89
    v_mfma_f32_16x16x32_bf16 v[116:119], v[52:55], v[232:235], v[116:119]
    v_rcp_f32 v90, v90
    v_rcp_f32 v91, v91
    v_mfma_f32_16x16x32_bf16 v[124:127], v[52:55], v[236:239], v[124:127]
    v_rcp_f32 v92, v92
    v_rcp_f32 v93, v93
    v_rcp_f32 v94, v94
    v_rcp_f32 v95, v95
    v_mul_f32 v32, v80, v96
    v_mul_f32 v33, v81, v97
    v_mul_f32 v34, v82, v98
    v_mul_f32 v35, v83, v99
    v_mul_f32 v36, v84, v100
    v_mul_f32 v37, v85, v101
    v_mul_f32 v38, v86, v102
    v_mul_f32 v39, v87, v103
    v_mul_f32 v40, v88, v104
    v_mul_f32 v41, v89, v105
    v_mul_f32 v42, v90, v106
    v_mul_f32 v43, v91, v107
    v_mul_f32 v44, v92, v108
    v_mul_f32 v45, v93, v109
    v_mul_f32 v46, v94, v110
    v_mul_f32 v47, v95, v111
    s_waitcnt lgkmcnt(0)
    v_exp_f32 v80, v112
    v_exp_f32 v81, v113
    v_smfmac_f32_16x16x64_bf16 v[128:131], v[20:23], v[32:39], v10 abid:1
    v_exp_f32 v82, v114
    v_exp_f32 v83, v115
    v_smfmac_f32_16x16x64_bf16 v[132:135], v[20:23], v[40:47], v10 abid:1
    v_exp_f32 v84, v116
    ds_read_b32 v14, v8 offset:128
    v_exp_f32 v85, v117
    ds_read_u16 v12, v9 offset:128
    ds_read_u16 v13, v9 offset:132
    v_mfma_f32_16x16x32_bf16 v[96:99], v[56:59], v[176:179], 0
    v_exp_f32 v86, v118
    v_exp_f32 v87, v119
    v_mfma_f32_16x16x32_bf16 v[104:107], v[56:59], v[180:183], 0
    v_exp_f32 v88, v120
    v_exp_f32 v89, v121
    v_mfma_f32_16x16x32_bf16 v[100:103], v[60:63], v[176:179], 0
    v_exp_f32 v90, v122
    v_exp_f32 v91, v123
    v_mfma_f32_16x16x32_bf16 v[108:111], v[60:63], v[180:183], 0
    v_exp_f32 v92, v124
    v_exp_f32 v93, v125
    v_mfma_f32_16x16x32_bf16 v[96:99], v[64:67], v[208:211], v[96:99]
    v_exp_f32 v94, v126
    v_exp_f32 v95, v127
    v_add_f32 v80, 1.0, v80
    v_add_f32 v81, 1.0, v81
    v_add_f32 v82, 1.0, v82
    v_add_f32 v83, 1.0, v83
    v_add_f32 v84, 1.0, v84
    v_add_f32 v85, 1.0, v85
    v_add_f32 v86, 1.0, v86
    v_add_f32 v87, 1.0, v87
    v_add_f32 v88, 1.0, v88
    v_add_f32 v89, 1.0, v89
    v_add_f32 v90, 1.0, v90
    v_add_f32 v91, 1.0, v91
    v_add_f32 v92, 1.0, v92
    v_add_f32 v93, 1.0, v93
    v_add_f32 v94, 1.0, v94
    v_add_f32 v95, 1.0, v95
    v_mfma_f32_16x16x32_bf16 v[104:107], v[64:67], v[212:215], v[104:107]
    v_rcp_f32 v80, v80
    v_rcp_f32 v81, v81
    v_mfma_f32_16x16x32_bf16 v[100:103], v[68:71], v[208:211], v[100:103]
    v_rcp_f32 v82, v82
    v_rcp_f32 v83, v83
    v_mfma_f32_16x16x32_bf16 v[108:111], v[68:71], v[212:215], v[108:111]
    v_rcp_f32 v84, v84
    v_rcp_f32 v85, v85
    v_mfma_f32_16x16x32_bf16 v[96:99], v[48:51], v[240:243], v[96:99]
    v_rcp_f32 v86, v86
    v_rcp_f32 v87, v87
    v_mfma_f32_16x16x32_bf16 v[104:107], v[48:51], v[244:247], v[104:107]
    v_rcp_f32 v88, v88
    v_rcp_f32 v89, v89
    v_mfma_f32_16x16x32_bf16 v[100:103], v[52:55], v[240:243], v[100:103]
    v_rcp_f32 v90, v90
    v_rcp_f32 v91, v91
    v_mfma_f32_16x16x32_bf16 v[108:111], v[52:55], v[244:247], v[108:111]
    v_rcp_f32 v92, v92
    v_rcp_f32 v93, v93
    v_rcp_f32 v94, v94
    v_rcp_f32 v95, v95
    s_waitcnt lgkmcnt(0)
    v_mul_f32 v32, v80, v112
    v_mul_f32 v33, v81, v113
    v_mul_f32 v34, v82, v114
    v_mul_f32 v35, v83, v115
    v_mul_f32 v36, v84, v116
    v_mul_f32 v37, v85, v117
    v_mul_f32 v38, v86, v118
    v_mul_f32 v39, v87, v119
    v_xor_b32_sdwa v15, v4, v14 dst_sel:DWORD dst_unused:UNUSED_PAD src0_sel:DWORD src1_sel:WORD_1
    v_xor_b32_sdwa v14, v4, v14 dst_sel:DWORD dst_unused:UNUSED_PAD src0_sel:DWORD src1_sel:WORD_0
    v_xad_u32 v12, v12, v29, v5
    v_xad_u32 v13, v13, v29, v5
    v_mul_f32 v40, v88, v120
    v_mul_f32 v41, v89, v121
    v_mul_f32 v42, v90, v122
    v_mul_f32 v43, v91, v123
    v_mul_f32 v44, v92, v124
    v_mul_f32 v45, v93, v125
    v_mul_f32 v46, v94, v126
    v_mul_f32 v47, v95, v127
    v_exp_f32 v80, v96
    v_exp_f32 v81, v97
    ds_read_b128 v[16:19], v6 offset:512
    v_smfmac_f32_16x16x64_bf16 v[136:139], v[20:23], v[32:39], v10 abid:1
    v_exp_f32 v82, v98
    ds_read_b32 v11, v7 offset:512
    v_exp_f32 v83, v99
    v_smfmac_f32_16x16x64_bf16 v[140:143], v[20:23], v[40:47], v10 abid:1
    v_exp_f32 v84, v100
    v_exp_f32 v85, v101
    s_waitcnt vmcnt(5)
    v_mfma_f32_16x16x32_bf16 v[112:115], v[56:59], v[184:187], 0
    v_exp_f32 v86, v102
    v_exp_f32 v87, v103
    v_mfma_f32_16x16x32_bf16 v[120:123], v[56:59], v[188:191], 0
    v_exp_f32 v88, v104
    ds_read_b128 v[56:59], v0 offset:0
    v_exp_f32 v89, v105
    v_mfma_f32_16x16x32_bf16 v[116:119], v[60:63], v[184:187], 0
    v_exp_f32 v90, v106
    v_exp_f32 v91, v107
    v_mfma_f32_16x16x32_bf16 v[124:127], v[60:63], v[188:191], 0
    v_exp_f32 v92, v108
    ds_read_b128 v[60:63], v0 offset:2048
    v_exp_f32 v93, v109
    v_mfma_f32_16x16x32_bf16 v[112:115], v[64:67], v[216:219], v[112:115]
    v_exp_f32 v94, v110
    v_exp_f32 v95, v111
    v_add_f32 v80, 1.0, v80
    v_add_f32 v81, 1.0, v81
    v_add_f32 v82, 1.0, v82
    v_add_f32 v83, 1.0, v83
    v_add_f32 v84, 1.0, v84
    v_add_f32 v85, 1.0, v85
    v_add_f32 v86, 1.0, v86
    v_add_f32 v87, 1.0, v87
    v_add_f32 v88, 1.0, v88
    v_add_f32 v89, 1.0, v89
    v_add_f32 v90, 1.0, v90
    v_add_f32 v91, 1.0, v91
    v_add_f32 v92, 1.0, v92
    v_add_f32 v93, 1.0, v93
    v_add_f32 v94, 1.0, v94
    v_add_f32 v95, 1.0, v95
    v_mfma_f32_16x16x32_bf16 v[120:123], v[64:67], v[220:223], v[120:123]
    v_rcp_f32 v80, v80
    ds_read_b128 v[64:67], v1 offset:0
    v_rcp_f32 v81, v81
    v_mfma_f32_16x16x32_bf16 v[116:119], v[68:71], v[216:219], v[116:119]
    v_rcp_f32 v82, v82
    v_rcp_f32 v83, v83
    v_mfma_f32_16x16x32_bf16 v[124:127], v[68:71], v[220:223], v[124:127]
    v_rcp_f32 v84, v84
    ds_read_b128 v[68:71], v1 offset:2048
    v_rcp_f32 v85, v85
    v_mfma_f32_16x16x32_bf16 v[112:115], v[48:51], v[248:251], v[112:115]
    v_rcp_f32 v86, v86
    v_rcp_f32 v87, v87
    v_mfma_f32_16x16x32_bf16 v[120:123], v[48:51], v[252:255], v[120:123]
    v_rcp_f32 v88, v88
    ds_read_b128 v[48:51], v12
    v_rcp_f32 v89, v89
    v_mfma_f32_16x16x32_bf16 v[116:119], v[52:55], v[248:251], v[116:119]
    v_rcp_f32 v90, v90
    v_rcp_f32 v91, v91
    v_mfma_f32_16x16x32_bf16 v[124:127], v[52:55], v[252:255], v[124:127]
    v_rcp_f32 v92, v92
    ds_read_b128 v[52:55], v13
    v_rcp_f32 v93, v93
    v_rcp_f32 v94, v94
    v_rcp_f32 v95, v95
    v_mul_f32 v32, v80, v96
    v_mul_f32 v33, v81, v97
    v_mul_f32 v34, v82, v98
    v_mul_f32 v35, v83, v99
    v_mul_f32 v36, v84, v100
    v_mul_f32 v37, v85, v101
    v_mul_f32 v38, v86, v102
    v_mul_f32 v39, v87, v103
    v_mul_f32 v40, v88, v104
    v_mul_f32 v41, v89, v105
    v_mul_f32 v42, v90, v106
    v_mul_f32 v43, v91, v107
    v_mul_f32 v44, v92, v108
    v_mul_f32 v45, v93, v109
    v_mul_f32 v46, v94, v110
    v_mul_f32 v47, v95, v111
    v_exp_f32 v80, v112
    v_exp_f32 v81, v113
    v_smfmac_f32_16x16x64_bf16 v[144:147], v[20:23], v[32:39], v10 abid:1
    v_exp_f32 v82, v114
    v_exp_f32 v83, v115
    v_smfmac_f32_16x16x64_bf16 v[148:151], v[20:23], v[40:47], v10 abid:1
    v_exp_f32 v84, v116
    v_exp_f32 v85, v117
    s_waitcnt lgkmcnt(0)
    v_mfma_f32_16x16x32_bf16 v[96:99], v[56:59], v[160:163], 0
    v_exp_f32 v86, v118
    v_exp_f32 v87, v119
    v_mfma_f32_16x16x32_bf16 v[104:107], v[56:59], v[164:167], 0
    v_exp_f32 v88, v120
    v_exp_f32 v89, v121
    v_mfma_f32_16x16x32_bf16 v[100:103], v[60:63], v[160:163], 0
    v_exp_f32 v90, v122
    v_exp_f32 v91, v123
    v_mfma_f32_16x16x32_bf16 v[108:111], v[60:63], v[164:167], 0
    v_exp_f32 v92, v124
    v_exp_f32 v93, v125
    v_mfma_f32_16x16x32_bf16 v[96:99], v[64:67], v[192:195], v[96:99]
    v_exp_f32 v94, v126
    v_exp_f32 v95, v127
    v_add_f32 v80, 1.0, v80
    v_add_f32 v81, 1.0, v81
    v_add_f32 v82, 1.0, v82
    v_add_f32 v83, 1.0, v83
    v_add_f32 v84, 1.0, v84
    v_add_f32 v85, 1.0, v85
    v_add_f32 v86, 1.0, v86
    v_add_f32 v87, 1.0, v87
    v_add_f32 v88, 1.0, v88
    v_add_f32 v89, 1.0, v89
    v_add_f32 v90, 1.0, v90
    v_add_f32 v91, 1.0, v91
    v_add_f32 v92, 1.0, v92
    v_add_f32 v93, 1.0, v93
    v_add_f32 v94, 1.0, v94
    v_add_f32 v95, 1.0, v95
    v_add_u32 v16, v16, v2
    v_xad_u32 v17, v2, 64, v17
    v_add_u32 v18, v18, v2
    v_xad_u32 v19, v2, 64, v19
    v_add_u32 v11, v11, v3
    v_add_u32 v6, 256, v6
    v_add_u32 v7, 256, v7
    v_add_u32 v8, 128, v8
    v_lshl_add_u32 v9, v3, 3, v9
    v_mfma_f32_16x16x32_bf16 v[104:107], v[64:67], v[196:199], v[104:107]
    v_rcp_f32 v80, v80
    s_add_u32 m0, s43, 0
    v_rcp_f32 v81, v81
    buffer_load_dwordx4 v16, s[12:15], 0 offen lds
    v_mfma_f32_16x16x32_bf16 v[100:103], v[68:71], v[192:195], v[100:103]
    v_rcp_f32 v82, v82
    s_add_u32 m0, s43, 1024
    v_rcp_f32 v83, v83
    buffer_load_dwordx4 v17, s[12:15], 0 offen lds
    v_mfma_f32_16x16x32_bf16 v[108:111], v[68:71], v[196:199], v[108:111]
    v_rcp_f32 v84, v84
    s_add_u32 m0, s43, 2048
    v_rcp_f32 v85, v85
    buffer_load_dwordx4 v18, s[12:15], 0 offen lds
    v_mfma_f32_16x16x32_bf16 v[96:99], v[48:51], v[224:227], v[96:99]
    v_rcp_f32 v86, v86
    s_add_u32 m0, s43, 3072
    v_rcp_f32 v87, v87
    buffer_load_dwordx4 v19, s[12:15], 0 offen lds
    v_mfma_f32_16x16x32_bf16 v[104:107], v[48:51], v[228:231], v[104:107]
    v_rcp_f32 v88, v88
    s_add_u32 m0, s43, 4096
    v_rcp_f32 v89, v89
    buffer_load_dwordx4 v11, s[16:19], 0 offen lds
    v_mfma_f32_16x16x32_bf16 v[100:103], v[52:55], v[224:227], v[100:103]
    v_rcp_f32 v90, v90
    v_rcp_f32 v91, v91
    v_mfma_f32_16x16x32_bf16 v[108:111], v[52:55], v[228:231], v[108:111]
    v_rcp_f32 v92, v92
    s_sub_u32 s42, s42, 1
    v_rcp_f32 v93, v93
    s_cmp_eq_u32 s42, 0
    v_rcp_f32 v94, v94
    v_rcp_f32 v95, v95
    v_mul_f32 v32, v80, v112
    v_mul_f32 v33, v81, v113
    v_mul_f32 v34, v82, v114
    v_mul_f32 v35, v83, v115
    v_mul_f32 v36, v84, v116
    v_mul_f32 v37, v85, v117
    v_mul_f32 v38, v86, v118
    v_mul_f32 v39, v87, v119
    v_mul_f32 v40, v88, v120
    v_mul_f32 v41, v89, v121
    v_mul_f32 v42, v90, v122
    v_mul_f32 v43, v91, v123
    v_mul_f32 v44, v92, v124
    v_mul_f32 v45, v93, v125
    v_mul_f32 v46, v94, v126
    v_mul_f32 v47, v95, v127
    s_cbranch_scc0 M_SLOOP
M_RARE:
    s_waitcnt lgkmcnt(0)
    s_nop 0
    v_smfmac_f32_16x16x64_bf16 v[152:155], v[20:23], v[32:39], v10 abid:1
    v_smfmac_f32_16x16x64_bf16 v[156:159], v[20:23], v[40:47], v10 abid:1
    v_cmp_ngt_f32 s[58:59], s63, v72
    v_cmp_ngt_f32 s[44:45], s63, v73
    v_cmp_ngt_f32 s[60:61], s63, v74
    v_cmp_ngt_f32 s[30:31], s63, v75
    v_and_b32 v30, 0x1800, v10
    s_or_b64 s[58:59], s[58:59], s[44:45]
    v_cmp_ne_u32 vcc, 0, v30
    s_or_b64 s[60:61], s[60:61], s[30:31]
    s_or_b64 s[58:59], s[58:59], s[60:61]
    s_cselect_b32 s44, s57, 1
    s_cmp_eq_u32 s44, 0
    s_cbranch_scc1 M_SAFE
    s_add_u32 s40, s40, 2048
    s_cmp_lt_u32 s40, s41
    s_cbranch_scc1 M_ROUND
    s_cmp_lg_u32 s57, 0
    s_cbranch_scc1 M_SE
    s_cbranch_vccnz M_EPI0
    s_branch M_SAFE
M_SE:
    v_mul_f32 v132, 0xbf31f21b, v132
    v_mul_f32 v133, 0xbf31f21b, v133
    v_mul_f32 v134, 0xbf31f21b, v134
    v_mul_f32 v135, 0xbf31f21b, v135
    v_mul_f32 v136, 0xbf31f21b, v136
    v_mul_f32 v137, 0xbf31f21b, v137
    v_mul_f32 v138, 0xbf31f21b, v138
    v_mul_f32 v139, 0xbf31f21b, v139
    v_mul_f32 v140, 0xbf31f21b, v140
    v_mul_f32 v141, 0xbf31f21b, v141
    v_mul_f32 v142, 0xbf31f21b, v142
    v_mul_f32 v143, 0xbf31f21b, v143
    v_mul_f32 v148, 0xbf31f21b, v148
    v_mul_f32 v149, 0xbf31f21b, v149
    v_mul_f32 v150, 0xbf31f21b, v150
    v_mul_f32 v151, 0xbf31f21b, v151
    v_mul_f32 v152, 0xbf31f21b, v152
    v_mul_f32 v153, 0xbf31f21b, v153
    v_mul_f32 v154, 0xbf31f21b, v154
    v_mul_f32 v155, 0xbf31f21b, v155
    v_mul_f32 v156, 0xbf31f21b, v156
    v_mul_f32 v157, 0xbf31f21b, v157
    v_mul_f32 v158, 0xbf31f21b, v158
    v_mul_f32 v159, 0xbf31f21b, v159
M_EPI0:
    s_waitcnt lgkmcnt(0)
    v_mov_b32 v32, 0
    v_mov_b32 v33, 0
    v_mov_b32 v34, 0
    v_mov_b32 v35, 0
    v_mov_b32 v36, 0
    v_mov_b32 v37, 0
    v_mov_b32 v38, 0
    v_mov_b32 v39, 0
    v_mov_b32 v40, 0
    v_mov_b32 v41, 0
    v_mov_b32 v42, 0
    v_mov_b32 v43, 0
    v_mov_b32 v44, 0
    v_mov_b32 v45, 0
    v_mov_b32 v46, 0
    v_mov_b32 v47, 0
    v_mov_b32 v20, 0
    v_mov_b32 v21, 0
    v_mov_b32 v22, 0
    v_mov_b32 v23, 0
    v_bfe_u32 v25, v28, 1, 3
    v_lshrrev_b32 v31, 4, v28
    v_lshlrev_b32 v26, 1, v31
    v_sub_u32 v25, v25, v26
    v_lshlrev_b32 v24, 4, v28
    v_cmp_eq_u32 vcc, 0, v25
    v_cmp_eq_u32 s[58:59], 1, v25
    v_mov_b32 v26, 0x3f80
    v_lshlrev_b32 v30, v24, v26
    v_cndmask_b32 v76, 0, v30, vcc
    v_cndmask_b32 v77, 0, v30, s[58:59]
    v_mov_b32 v78, 0
    v_mov_b32 v79, 0
    v_and_b32 v30, 15, v28
    v_lshl_add_u32 v25, v30, 4, s48
    s_mov_b32 s44, 156160
    v_lshl_add_u32 v26, v31, 5, s44
    v_subrev_u32 v30, s38, v30
    v_and_b32 v30, 15, v30
    v_add_u32 v30, s38, v30
    v_cmp_gt_u32 vcc, s39, v30
    v_lshlrev_b32 v30, 7, v30
    v_lshl_add_u32 v30, v31, 4, v30
    v_mov_b32 v31, 0x7fffff00
    v_cndmask_b32 v27, v31, v30, vcc
    s_branch M_EPI
M_SAFE:
    s_mov_b32 s57, 1
    s_mov_b32 s40, 0
    s_waitcnt vmcnt(0) lgkmcnt(0)
    s_mov_b32 s44, 0xc00008
    s_mov_b32 s45, 400000
M_SW:
    s_sub_u32 s45, s45, 1
    s_cbranch_scc1 M_END
    buffer_load_dword v30, off, s[20:23], s44 sc1
    s_waitcnt vmcnt(0)
    v_cmp_ne_u32 vcc, 0xff, v30
    s_cbranch_vccnz M_SW
    v_lshlrev_b32 v24, 4, v28
    v_and_b32 v25, 48, v28
    v_and_b32 v31, 3, v28
    v_bfe_u32 v30, v28, 2, 1
    v_lshl_or_b32 v31, v30, 3, v31
    v_bfe_u32 v30, v28, 3, 1
    v_lshl_or_b32 v31, v30, 2, v31
    v_subrev_u32 v31, s38, v31
    v_and_b32 v31, 15, v31
    v_add_u32 v31, s38, v31
    v_lshl_add_u32 v31, v31, 7, v25
    buffer_load_dwordx4 v[56:59], v31, s[12:15], 0 offen offset:0
    buffer_load_dwordx4 v[60:63], v31, s[12:15], 0 offen offset:64
    s_mov_b32 s44, 0x1100000
    buffer_load_dwordx4 v[160:163], v24, s[20:23], s44 offen sc1
    s_mov_b32 s44, 0x1100400
    buffer_load_dwordx4 v[164:167], v24, s[20:23], s44 offen sc1
    s_mov_b32 s44, 0x1100800
    buffer_load_dwordx4 v[168:171], v24, s[20:23], s44 offen sc1
    s_mov_b32 s44, 0x1100c00
    buffer_load_dwordx4 v[172:175], v24, s[20:23], s44 offen sc1
    s_mov_b32 s44, 0x1101000
    buffer_load_dwordx4 v[176:179], v24, s[20:23], s44 offen sc1
    s_mov_b32 s44, 0x1101400
    buffer_load_dwordx4 v[180:183], v24, s[20:23], s44 offen sc1
    s_mov_b32 s44, 0x1101800
    buffer_load_dwordx4 v[184:187], v24, s[20:23], s44 offen sc1
    s_mov_b32 s44, 0x1101c00
    buffer_load_dwordx4 v[188:191], v24, s[20:23], s44 offen sc1
    s_mov_b32 s44, 0x1102000
    buffer_load_dwordx4 v[192:195], v24, s[20:23], s44 offen sc1
    s_mov_b32 s44, 0x1102400
    buffer_load_dwordx4 v[196:199], v24, s[20:23], s44 offen sc1
    s_mov_b32 s44, 0x1102800
    buffer_load_dwordx4 v[200:203], v24, s[20:23], s44 offen sc1
    s_mov_b32 s44, 0x1102c00
    buffer_load_dwordx4 v[204:207], v24, s[20:23], s44 offen sc1
    s_mov_b32 s44, 0x1103000
    buffer_load_dwordx4 v[208:211], v24, s[20:23], s44 offen sc1
    s_mov_b32 s44, 0x1103400
    buffer_load_dwordx4 v[212:215], v24, s[20:23], s44 offen sc1
    s_mov_b32 s44, 0x1103800
    buffer_load_dwordx4 v[216:219], v24, s[20:23], s44 offen sc1
    s_mov_b32 s44, 0x1103c00
    buffer_load_dwordx4 v[220:223], v24, s[20:23], s44 offen sc1
    s_mov_b32 s44, 0x1104000
    buffer_load_dwordx4 v[96:99], v24, s[20:23], s44 offen sc1
    s_mov_b32 s44, 0x1104400
    buffer_load_dwordx4 v[100:103], v24, s[20:23], s44 offen sc1
    s_mov_b32 s44, 0x1104800
    buffer_load_dwordx4 v[104:107], v24, s[20:23], s44 offen sc1
    s_mov_b32 s44, 0x1104c00
    buffer_load_dwordx4 v[108:111], v24, s[20:23], s44 offen sc1
    s_mov_b32 s44, 0x1105000
    buffer_load_dwordx4 v[112:115], v24, s[20:23], s44 offen sc1
    s_mov_b32 s44, 0x1105400
    buffer_load_dwordx4 v[116:119], v24, s[20:23], s44 offen sc1
    s_mov_b32 s44, 0x1105800
    buffer_load_dwordx4 v[120:123], v24, s[20:23], s44 offen sc1
    s_mov_b32 s44, 0x1105c00
    buffer_load_dwordx4 v[124:127], v24, s[20:23], s44 offen sc1
    s_mov_b32 s44, 0x1106000
    buffer_load_dwordx4 v[128:131], v24, s[20:23], s44 offen sc1
    s_mov_b32 s44, 0x1106400
    buffer_load_dwordx4 v[132:135], v24, s[20:23], s44 offen sc1
    s_mov_b32 s44, 0x1106800
    buffer_load_dwordx4 v[136:139], v24, s[20:23], s44 offen sc1
    s_mov_b32 s44, 0x1106c00
    buffer_load_dwordx4 v[140:143], v24, s[20:23], s44 offen sc1
    s_mov_b32 s44, 0x1107000
    buffer_load_dwordx4 v[144:147], v24, s[20:23], s44 offen sc1
    s_mov_b32 s44, 0x1107400
    buffer_load_dwordx4 v[148:151], v24, s[20:23], s44 offen sc1
    s_mov_b32 s44, 0x1107800
    buffer_load_dwordx4 v[152:155], v24, s[20:23], s44 offen sc1
    s_mov_b32 s44, 0x1107c00
    buffer_load_dwordx4 v[156:159], v24, s[20:23], s44 offen sc1
    v_lshlrev_b32 v14, 3, v28
    s_mov_b32 s44, 0x1108000
    buffer_load_dwordx2 v[224:225], v14, s[20:23], s44 offen sc1
    s_mov_b32 s44, 0x1108400
    buffer_load_dwordx2 v[228:229], v14, s[20:23], s44 offen sc1
    s_mov_b32 s44, 0x1108800
    buffer_load_dwordx2 v[232:233], v14, s[20:23], s44 offen sc1
    s_mov_b32 s44, 0x1108c00
    buffer_load_dwordx2 v[236:237], v14, s[20:23], s44 offen sc1
    s_mov_b32 s44, 0x1109000
    buffer_load_dwordx2 v[240:241], v14, s[20:23], s44 offen sc1
    s_mov_b32 s44, 0x1109400
    buffer_load_dwordx2 v[244:245], v14, s[20:23], s44 offen sc1
    s_mov_b32 s44, 0x1109800
    buffer_load_dwordx2 v[248:249], v14, s[20:23], s44 offen sc1
    s_mov_b32 s44, 0x1109c00
    buffer_load_dwordx2 v[252:253], v14, s[20:23], s44 offen sc1
    v_lshl_add_u32 v31, v28, 3, s48
    v_mov_b32 v80, 0
    v_mov_b32 v81, 0
    s_mov_b32 exec_hi, 3
    ds_write_b64 v31, v[80:81]
    s_mov_b64 exec, -1
    v_and_b32 v23, 15, v28
    v_lshlrev_b32 v23, 5, v23
    v_add_u32 v23, 155648, v23
    ds_read_b128 v[40:43], v23 offset:0
    ds_read_b128 v[44:47], v23 offset:16
    s_mov_b32 s60, 0xbfb8aa3b
    s_mov_b32 s61, 0xbfb8aa3b
    s_waitcnt vmcnt(0) lgkmcnt(0)
    v_lshlrev_b32 v31, 16, v160
    v_and_b32 v30, 0xffff0000, v160
    v_mul_f32 v31, s60, v31
    v_mul_f32 v30, s60, v30
    v_cvt_pk_bf16_f32 v160, v31, v30
    v_lshlrev_b32 v31, 16, v161
    v_and_b32 v30, 0xffff0000, v161
    v_mul_f32 v31, s60, v31
    v_mul_f32 v30, s60, v30
    v_cvt_pk_bf16_f32 v161, v31, v30
    v_lshlrev_b32 v31, 16, v162
    v_and_b32 v30, 0xffff0000, v162
    v_mul_f32 v31, s60, v31
    v_mul_f32 v30, s60, v30
    v_cvt_pk_bf16_f32 v162, v31, v30
    v_lshlrev_b32 v31, 16, v163
    v_and_b32 v30, 0xffff0000, v163
    v_mul_f32 v31, s60, v31
    v_mul_f32 v30, s60, v30
    v_cvt_pk_bf16_f32 v163, v31, v30
    v_lshlrev_b32 v31, 16, v164
    v_and_b32 v30, 0xffff0000, v164
    v_mul_f32 v31, s60, v31
    v_mul_f32 v30, s60, v30
    v_cvt_pk_bf16_f32 v164, v31, v30
    v_lshlrev_b32 v31, 16, v165
    v_and_b32 v30, 0xffff0000, v165
    v_mul_f32 v31, s60, v31
    v_mul_f32 v30, s60, v30
    v_cvt_pk_bf16_f32 v165, v31, v30
    v_lshlrev_b32 v31, 16, v166
    v_and_b32 v30, 0xffff0000, v166
    v_mul_f32 v31, s60, v31
    v_mul_f32 v30, s60, v30
    v_cvt_pk_bf16_f32 v166, v31, v30
    v_lshlrev_b32 v31, 16, v167
    v_and_b32 v30, 0xffff0000, v167
    v_mul_f32 v31, s60, v31
    v_mul_f32 v30, s60, v30
    v_cvt_pk_bf16_f32 v167, v31, v30
    v_lshlrev_b32 v31, 16, v168
    v_and_b32 v30, 0xffff0000, v168
    v_mul_f32 v31, s60, v31
    v_mul_f32 v30, s60, v30
    v_cvt_pk_bf16_f32 v168, v31, v30
    v_lshlrev_b32 v31, 16, v169
    v_and_b32 v30, 0xffff0000, v169
    v_mul_f32 v31, s60, v31
    v_mul_f32 v30, s60, v30
    v_cvt_pk_bf16_f32 v169, v31, v30
    v_lshlrev_b32 v31, 16, v170
    v_and_b32 v30, 0xffff0000, v170
    v_mul_f32 v31, s60, v31
    v_mul_f32 v30, s60, v30
    v_cvt_pk_bf16_f32 v170, v31, v30
    v_lshlrev_b32 v31, 16, v171
    v_and_b32 v30, 0xffff0000, v171
    v_mul_f32 v31, s60, v31
    v_mul_f32 v30, s60, v30
    v_cvt_pk_bf16_f32 v171, v31, v30
    v_lshlrev_b32 v31, 16, v172
    v_and_b32 v30, 0xffff0000, v172
    v_mul_f32 v31, s60, v31
    v_mul_f32 v30, s60, v30
    v_cvt_pk_bf16_f32 v172, v31, v30
    v_lshlrev_b32 v31, 16, v173
    v_and_b32 v30, 0xffff0000, v173
    v_mul_f32 v31, s60, v31
    v_mul_f32 v30, s60, v30
    v_cvt_pk_bf16_f32 v173, v31, v30
    v_lshlrev_b32 v31, 16, v174
    v_and_b32 v30, 0xffff0000, v174
    v_mul_f32 v31, s60, v31
    v_mul_f32 v30, s60, v30
    v_cvt_pk_bf16_f32 v174, v31, v30
    v_lshlrev_b32 v31, 16, v175
    v_and_b32 v30, 0xffff0000, v175
    v_mul_f32 v31, s60, v31
    v_mul_f32 v30, s60, v30
    v_cvt_pk_bf16_f32 v175, v31, v30
    v_lshlrev_b32 v31, 16, v176
    v_and_b32 v30, 0xffff0000, v176
    v_mul_f32 v31, s60, v31
    v_mul_f32 v30, s60, v30
    v_cvt_pk_bf16_f32 v176, v31, v30
    v_lshlrev_b32 v31, 16, v177
    v_and_b32 v30, 0xffff0000, v177
    v_mul_f32 v31, s60, v31
    v_mul_f32 v30, s60, v30
    v_cvt_pk_bf16_f32 v177, v31, v30
    v_lshlrev_b32 v31, 16, v178
    v_and_b32 v30, 0xffff0000, v178
    v_mul_f32 v31, s60, v31
    v_mul_f32 v30, s60, v30
    v_cvt_pk_bf16_f32 v178, v31, v30
    v_lshlrev_b32 v31, 16, v179
    v_and_b32 v30, 0xffff0000, v179
    v_mul_f32 v31, s60, v31
    v_mul_f32 v30, s60, v30
    v_cvt_pk_bf16_f32 v179, v31, v30
    v_lshlrev_b32 v31, 16, v180
    v_and_b32 v30, 0xffff0000, v180
    v_mul_f32 v31, s60, v31
    v_mul_f32 v30, s60, v30
    v_cvt_pk_bf16_f32 v180, v31, v30
    v_lshlrev_b32 v31, 16, v181
    v_and_b32 v30, 0xffff0000, v181
    v_mul_f32 v31, s60, v31
    v_mul_f32 v30, s60, v30
    v_cvt_pk_bf16_f32 v181, v31, v30
    v_lshlrev_b32 v31, 16, v182
    v_and_b32 v30, 0xffff0000, v182
    v_mul_f32 v31, s60, v31
    v_mul_f32 v30, s60, v30
    v_cvt_pk_bf16_f32 v182, v31, v30
    v_lshlrev_b32 v31, 16, v183
    v_and_b32 v30, 0xffff0000, v183
    v_mul_f32 v31, s60, v31
    v_mul_f32 v30, s60, v30
    v_cvt_pk_bf16_f32 v183, v31, v30
    v_lshlrev_b32 v31, 16, v184
    v_and_b32 v30, 0xffff0000, v184
    v_mul_f32 v31, s60, v31
    v_mul_f32 v30, s60, v30
    v_cvt_pk_bf16_f32 v184, v31, v30
    v_lshlrev_b32 v31, 16, v185
    v_and_b32 v30, 0xffff0000, v185
    v_mul_f32 v31, s60, v31
    v_mul_f32 v30, s60, v30
    v_cvt_pk_bf16_f32 v185, v31, v30
    v_lshlrev_b32 v31, 16, v186
    v_and_b32 v30, 0xffff0000, v186
    v_mul_f32 v31, s60, v31
    v_mul_f32 v30, s60, v30
    v_cvt_pk_bf16_f32 v186, v31, v30
    v_lshlrev_b32 v31, 16, v187
    v_and_b32 v30, 0xffff0000, v187
    v_mul_f32 v31, s60, v31
    v_mul_f32 v30, s60, v30
    v_cvt_pk_bf16_f32 v187, v31, v30
    v_lshlrev_b32 v31, 16, v188
    v_and_b32 v30, 0xffff0000, v188
    v_mul_f32 v31, s60, v31
    v_mul_f32 v30, s60, v30
    v_cvt_pk_bf16_f32 v188, v31, v30
    v_lshlrev_b32 v31, 16, v189
    v_and_b32 v30, 0xffff0000, v189
    v_mul_f32 v31, s60, v31
    v_mul_f32 v30, s60, v30
    v_cvt_pk_bf16_f32 v189, v31, v30
    v_lshlrev_b32 v31, 16, v190
    v_and_b32 v30, 0xffff0000, v190
    v_mul_f32 v31, s60, v31
    v_mul_f32 v30, s60, v30
    v_cvt_pk_bf16_f32 v190, v31, v30
    v_lshlrev_b32 v31, 16, v191
    v_and_b32 v30, 0xffff0000, v191
    v_mul_f32 v31, s60, v31
    v_mul_f32 v30, s60, v30
    v_cvt_pk_bf16_f32 v191, v31, v30
    v_lshlrev_b32 v31, 16, v192
    v_and_b32 v30, 0xffff0000, v192
    v_mul_f32 v31, s60, v31
    v_mul_f32 v30, s60, v30
    v_cvt_pk_bf16_f32 v192, v31, v30
    v_lshlrev_b32 v31, 16, v193
    v_and_b32 v30, 0xffff0000, v193
    v_mul_f32 v31, s60, v31
    v_mul_f32 v30, s60, v30
    v_cvt_pk_bf16_f32 v193, v31, v30
    v_lshlrev_b32 v31, 16, v194
    v_and_b32 v30, 0xffff0000, v194
    v_mul_f32 v31, s60, v31
    v_mul_f32 v30, s60, v30
    v_cvt_pk_bf16_f32 v194, v31, v30
    v_lshlrev_b32 v31, 16, v195
    v_and_b32 v30, 0xffff0000, v195
    v_mul_f32 v31, s60, v31
    v_mul_f32 v30, s60, v30
    v_cvt_pk_bf16_f32 v195, v31, v30
    v_lshlrev_b32 v31, 16, v196
    v_and_b32 v30, 0xffff0000, v196
    v_mul_f32 v31, s60, v31
    v_mul_f32 v30, s60, v30
    v_cvt_pk_bf16_f32 v196, v31, v30
    v_lshlrev_b32 v31, 16, v197
    v_and_b32 v30, 0xffff0000, v197
    v_mul_f32 v31, s60, v31
    v_mul_f32 v30, s60, v30
    v_cvt_pk_bf16_f32 v197, v31, v30
    v_lshlrev_b32 v31, 16, v198
    v_and_b32 v30, 0xffff0000, v198
    v_mul_f32 v31, s60, v31
    v_mul_f32 v30, s60, v30
    v_cvt_pk_bf16_f32 v198, v31, v30
    v_lshlrev_b32 v31, 16, v199
    v_and_b32 v30, 0xffff0000, v199
    v_mul_f32 v31, s60, v31
    v_mul_f32 v30, s60, v30
    v_cvt_pk_bf16_f32 v199, v31, v30
    v_lshlrev_b32 v31, 16, v200
    v_and_b32 v30, 0xffff0000, v200
    v_mul_f32 v31, s60, v31
    v_mul_f32 v30, s60, v30
    v_cvt_pk_bf16_f32 v200, v31, v30
    v_lshlrev_b32 v31, 16, v201
    v_and_b32 v30, 0xffff0000, v201
    v_mul_f32 v31, s60, v31
    v_mul_f32 v30, s60, v30
    v_cvt_pk_bf16_f32 v201, v31, v30
    v_lshlrev_b32 v31, 16, v202
    v_and_b32 v30, 0xffff0000, v202
    v_mul_f32 v31, s60, v31
    v_mul_f32 v30, s60, v30
    v_cvt_pk_bf16_f32 v202, v31, v30
    v_lshlrev_b32 v31, 16, v203
    v_and_b32 v30, 0xffff0000, v203
    v_mul_f32 v31, s60, v31
    v_mul_f32 v30, s60, v30
    v_cvt_pk_bf16_f32 v203, v31, v30
    v_lshlrev_b32 v31, 16, v204
    v_and_b32 v30, 0xffff0000, v204
    v_mul_f32 v31, s60, v31
    v_mul_f32 v30, s60, v30
    v_cvt_pk_bf16_f32 v204, v31, v30
    v_lshlrev_b32 v31, 16, v205
    v_and_b32 v30, 0xffff0000, v205
    v_mul_f32 v31, s60, v31
    v_mul_f32 v30, s60, v30
    v_cvt_pk_bf16_f32 v205, v31, v30
    v_lshlrev_b32 v31, 16, v206
    v_and_b32 v30, 0xffff0000, v206
    v_mul_f32 v31, s60, v31
    v_mul_f32 v30, s60, v30
    v_cvt_pk_bf16_f32 v206, v31, v30
    v_lshlrev_b32 v31, 16, v207
    v_and_b32 v30, 0xffff0000, v207
    v_mul_f32 v31, s60, v31
    v_mul_f32 v30, s60, v30
    v_cvt_pk_bf16_f32 v207, v31, v30
    v_lshlrev_b32 v31, 16, v208
    v_and_b32 v30, 0xffff0000, v208
    v_mul_f32 v31, s60, v31
    v_mul_f32 v30, s60, v30
    v_cvt_pk_bf16_f32 v208, v31, v30
    v_lshlrev_b32 v31, 16, v209
    v_and_b32 v30, 0xffff0000, v209
    v_mul_f32 v31, s60, v31
    v_mul_f32 v30, s60, v30
    v_cvt_pk_bf16_f32 v209, v31, v30
    v_lshlrev_b32 v31, 16, v210
    v_and_b32 v30, 0xffff0000, v210
    v_mul_f32 v31, s60, v31
    v_mul_f32 v30, s60, v30
    v_cvt_pk_bf16_f32 v210, v31, v30
    v_lshlrev_b32 v31, 16, v211
    v_and_b32 v30, 0xffff0000, v211
    v_mul_f32 v31, s60, v31
    v_mul_f32 v30, s60, v30
    v_cvt_pk_bf16_f32 v211, v31, v30
    v_lshlrev_b32 v31, 16, v212
    v_and_b32 v30, 0xffff0000, v212
    v_mul_f32 v31, s60, v31
    v_mul_f32 v30, s60, v30
    v_cvt_pk_bf16_f32 v212, v31, v30
    v_lshlrev_b32 v31, 16, v213
    v_and_b32 v30, 0xffff0000, v213
    v_mul_f32 v31, s60, v31
    v_mul_f32 v30, s60, v30
    v_cvt_pk_bf16_f32 v213, v31, v30
    v_lshlrev_b32 v31, 16, v214
    v_and_b32 v30, 0xffff0000, v214
    v_mul_f32 v31, s60, v31
    v_mul_f32 v30, s60, v30
    v_cvt_pk_bf16_f32 v214, v31, v30
    v_lshlrev_b32 v31, 16, v215
    v_and_b32 v30, 0xffff0000, v215
    v_mul_f32 v31, s60, v31
    v_mul_f32 v30, s60, v30
    v_cvt_pk_bf16_f32 v215, v31, v30
    v_lshlrev_b32 v31, 16, v216
    v_and_b32 v30, 0xffff0000, v216
    v_mul_f32 v31, s60, v31
    v_mul_f32 v30, s60, v30
    v_cvt_pk_bf16_f32 v216, v31, v30
    v_lshlrev_b32 v31, 16, v217
    v_and_b32 v30, 0xffff0000, v217
    v_mul_f32 v31, s60, v31
    v_mul_f32 v30, s60, v30
    v_cvt_pk_bf16_f32 v217, v31, v30
    v_lshlrev_b32 v31, 16, v218
    v_and_b32 v30, 0xffff0000, v218
    v_mul_f32 v31, s60, v31
    v_mul_f32 v30, s60, v30
    v_cvt_pk_bf16_f32 v218, v31, v30
    v_lshlrev_b32 v31, 16, v219
    v_and_b32 v30, 0xffff0000, v219
    v_mul_f32 v31, s60, v31
    v_mul_f32 v30, s60, v30
    v_cvt_pk_bf16_f32 v219, v31, v30
    v_lshlrev_b32 v31, 16, v220
    v_and_b32 v30, 0xffff0000, v220
    v_mul_f32 v31, s60, v31
    v_mul_f32 v30, s60, v30
    v_cvt_pk_bf16_f32 v220, v31, v30
    v_lshlrev_b32 v31, 16, v221
    v_and_b32 v30, 0xffff0000, v221
    v_mul_f32 v31, s60, v31
    v_mul_f32 v30, s60, v30
    v_cvt_pk_bf16_f32 v221, v31, v30
    v_lshlrev_b32 v31, 16, v222
    v_and_b32 v30, 0xffff0000, v222
    v_mul_f32 v31, s60, v31
    v_mul_f32 v30, s60, v30
    v_cvt_pk_bf16_f32 v222, v31, v30
    v_lshlrev_b32 v31, 16, v223
    v_and_b32 v30, 0xffff0000, v223
    v_mul_f32 v31, s60, v31
    v_mul_f32 v30, s60, v30
    v_cvt_pk_bf16_f32 v223, v31, v30
    v_lshlrev_b32 v31, 16, v224
    v_and_b32 v30, 0xffff0000, v224
    v_mul_f32 v31, s60, v31
    v_mul_f32 v30, s60, v30
    v_cvt_pk_bf16_f32 v224, v31, v30
    v_lshlrev_b32 v31, 16, v225
    v_and_b32 v30, 0xffff0000, v225
    v_mul_f32 v31, s60, v31
    v_mul_f32 v30, s60, v30
    v_cvt_pk_bf16_f32 v225, v31, v30
    v_lshlrev_b32 v31, 16, v228
    v_and_b32 v30, 0xffff0000, v228
    v_mul_f32 v31, s60, v31
    v_mul_f32 v30, s60, v30
    v_cvt_pk_bf16_f32 v228, v31, v30
    v_lshlrev_b32 v31, 16, v229
    v_and_b32 v30, 0xffff0000, v229
    v_mul_f32 v31, s60, v31
    v_mul_f32 v30, s60, v30
    v_cvt_pk_bf16_f32 v229, v31, v30
    v_lshlrev_b32 v31, 16, v232
    v_and_b32 v30, 0xffff0000, v232
    v_mul_f32 v31, s60, v31
    v_mul_f32 v30, s60, v30
    v_cvt_pk_bf16_f32 v232, v31, v30
    v_lshlrev_b32 v31, 16, v233
    v_and_b32 v30, 0xffff0000, v233
    v_mul_f32 v31, s60, v31
    v_mul_f32 v30, s60, v30
    v_cvt_pk_bf16_f32 v233, v31, v30
    v_lshlrev_b32 v31, 16, v236
    v_and_b32 v30, 0xffff0000, v236
    v_mul_f32 v31, s60, v31
    v_mul_f32 v30, s60, v30
    v_cvt_pk_bf16_f32 v236, v31, v30
    v_lshlrev_b32 v31, 16, v237
    v_and_b32 v30, 0xffff0000, v237
    v_mul_f32 v31, s60, v31
    v_mul_f32 v30, s60, v30
    v_cvt_pk_bf16_f32 v237, v31, v30
    v_lshlrev_b32 v31, 16, v240
    v_and_b32 v30, 0xffff0000, v240
    v_mul_f32 v31, s60, v31
    v_mul_f32 v30, s60, v30
    v_cvt_pk_bf16_f32 v240, v31, v30
    v_lshlrev_b32 v31, 16, v241
    v_and_b32 v30, 0xffff0000, v241
    v_mul_f32 v31, s60, v31
    v_mul_f32 v30, s60, v30
    v_cvt_pk_bf16_f32 v241, v31, v30
    v_lshlrev_b32 v31, 16, v244
    v_and_b32 v30, 0xffff0000, v244
    v_mul_f32 v31, s60, v31
    v_mul_f32 v30, s60, v30
    v_cvt_pk_bf16_f32 v244, v31, v30
    v_lshlrev_b32 v31, 16, v245
    v_and_b32 v30, 0xffff0000, v245
    v_mul_f32 v31, s60, v31
    v_mul_f32 v30, s60, v30
    v_cvt_pk_bf16_f32 v245, v31, v30
    v_lshlrev_b32 v31, 16, v248
    v_and_b32 v30, 0xffff0000, v248
    v_mul_f32 v31, s60, v31
    v_mul_f32 v30, s60, v30
    v_cvt_pk_bf16_f32 v248, v31, v30
    v_lshlrev_b32 v31, 16, v249
    v_and_b32 v30, 0xffff0000, v249
    v_mul_f32 v31, s60, v31
    v_mul_f32 v30, s60, v30
    v_cvt_pk_bf16_f32 v249, v31, v30
    v_lshlrev_b32 v31, 16, v252
    v_and_b32 v30, 0xffff0000, v252
    v_mul_f32 v31, s60, v31
    v_mul_f32 v30, s60, v30
    v_cvt_pk_bf16_f32 v252, v31, v30
    v_lshlrev_b32 v31, 16, v253
    v_and_b32 v30, 0xffff0000, v253
    v_mul_f32 v31, s60, v31
    v_mul_f32 v30, s60, v30
    v_cvt_pk_bf16_f32 v253, v31, v30
    v_mfma_f32_16x16x32_bf16 v[64:67], v[56:59], v[96:99], 0
    v_mul_f32 v40, s60, v40
    v_mfma_f32_16x16x32_bf16 v[68:71], v[56:59], v[100:103], 0
    v_mul_f32 v41, s61, v41
    v_mfma_f32_16x16x32_bf16 v[72:75], v[56:59], v[104:107], 0
    v_mul_f32 v42, s61, v42
    v_mfma_f32_16x16x32_bf16 v[76:79], v[56:59], v[108:111], 0
    v_mul_f32 v43, s61, v43
    v_mfma_f32_16x16x32_bf16 v[80:83], v[56:59], v[112:115], 0
    v_mul_f32 v44, s60, v44
    v_mfma_f32_16x16x32_bf16 v[84:87], v[56:59], v[116:119], 0
    v_mul_f32 v45, s61, v45
    v_mfma_f32_16x16x32_bf16 v[88:91], v[56:59], v[120:123], 0
    v_mul_f32 v46, s61, v46
    v_mfma_f32_16x16x32_bf16 v[92:95], v[56:59], v[124:127], 0
    v_mul_f32 v47, s61, v47
    v_mfma_f32_16x16x32_bf16 v[64:67], v[60:63], v[128:131], v[64:67]
    v_mov_b32 v36, 0
    v_mfma_f32_16x16x32_bf16 v[68:71], v[60:63], v[132:135], v[68:71]
    v_mov_b32 v37, 0
    v_mfma_f32_16x16x32_bf16 v[72:75], v[60:63], v[136:139], v[72:75]
    v_mov_b32 v38, 0
    v_mfma_f32_16x16x32_bf16 v[76:79], v[60:63], v[140:143], v[76:79]
    v_mov_b32 v39, 0
    v_mfma_f32_16x16x32_bf16 v[80:83], v[60:63], v[144:147], v[80:83]
    v_mfma_f32_16x16x32_bf16 v[84:87], v[60:63], v[148:151], v[84:87]
    v_mfma_f32_16x16x32_bf16 v[88:91], v[60:63], v[152:155], v[88:91]
    v_mfma_f32_16x16x32_bf16 v[92:95], v[60:63], v[156:159], v[92:95]
    v_mfma_f32_32x32x16_bf16 v[128:143], v[36:39], v[36:39], 0
    v_fma_f32 v64, v64, s60, v40
    v_fma_f32 v65, v65, s60, v40
    v_fma_f32 v66, v66, s60, v40
    v_fma_f32 v67, v67, s60, v40
    v_cvt_pk_bf16_f32 v226, v64, v65
    v_cvt_pk_bf16_f32 v227, v66, v67
    v_fma_f32 v68, v68, s61, v41
    v_fma_f32 v69, v69, s61, v41
    v_fma_f32 v70, v70, s61, v41
    v_fma_f32 v71, v71, s61, v41
    v_permlane32_swap_b32 v224, v226
    v_permlane32_swap_b32 v225, v227
    v_cvt_pk_bf16_f32 v230, v68, v69
    v_cvt_pk_bf16_f32 v231, v70, v71
    v_mfma_f32_32x32x16_bf16 v[144:159], v[36:39], v[36:39], 0
    v_fma_f32 v72, v72, s61, v42
    v_fma_f32 v73, v73, s61, v42
    v_fma_f32 v74, v74, s61, v42
    v_fma_f32 v75, v75, s61, v42
    v_permlane32_swap_b32 v228, v230
    v_permlane32_swap_b32 v229, v231
    v_cvt_pk_bf16_f32 v234, v72, v73
    v_cvt_pk_bf16_f32 v235, v74, v75
    v_fma_f32 v76, v76, s61, v43
    v_fma_f32 v77, v77, s61, v43
    v_fma_f32 v78, v78, s61, v43
    v_fma_f32 v79, v79, s61, v43
    v_permlane32_swap_b32 v232, v234
    v_permlane32_swap_b32 v233, v235
    v_cvt_pk_bf16_f32 v238, v76, v77
    v_cvt_pk_bf16_f32 v239, v78, v79
    v_fma_f32 v80, v80, s60, v44
    v_fma_f32 v81, v81, s60, v44
    v_fma_f32 v82, v82, s60, v44
    v_fma_f32 v83, v83, s60, v44
    v_permlane32_swap_b32 v236, v238
    v_permlane32_swap_b32 v237, v239
    v_cvt_pk_bf16_f32 v242, v80, v81
    v_cvt_pk_bf16_f32 v243, v82, v83
    v_fma_f32 v84, v84, s61, v45
    v_fma_f32 v85, v85, s61, v45
    v_fma_f32 v86, v86, s61, v45
    v_fma_f32 v87, v87, s61, v45
    v_permlane32_swap_b32 v240, v242
    v_permlane32_swap_b32 v241, v243
    v_cvt_pk_bf16_f32 v246, v84, v85
    v_cvt_pk_bf16_f32 v247, v86, v87
    v_fma_f32 v88, v88, s61, v46
    v_fma_f32 v89, v89, s61, v46
    v_fma_f32 v90, v90, s61, v46
    v_fma_f32 v91, v91, s61, v46
    v_permlane32_swap_b32 v244, v246
    v_permlane32_swap_b32 v245, v247
    v_cvt_pk_bf16_f32 v250, v88, v89
    v_cvt_pk_bf16_f32 v251, v90, v91
    v_fma_f32 v92, v92, s61, v47
    v_fma_f32 v93, v93, s61, v47
    v_fma_f32 v94, v94, s61, v47
    v_fma_f32 v95, v95, s61, v47
    v_permlane32_swap_b32 v248, v250
    v_permlane32_swap_b32 v249, v251
    v_cvt_pk_bf16_f32 v254, v92, v93
    v_cvt_pk_bf16_f32 v255, v94, v95
    s_nop 0
    v_permlane32_swap_b32 v252, v254
    v_permlane32_swap_b32 v253, v255
    s_branch M_ROUND
.section .rodata,"a"
.p2align 6
.amdhsa_kernel standalone__edge_featured_mpnn_mpnn__graph_kernel
  .amdhsa_next_free_vgpr 256
  .amdhsa_next_free_sgpr 64
  .amdhsa_accum_offset 256
  .amdhsa_group_segment_fixed_size 0
  .amdhsa_kernarg_size 88
  .amdhsa_user_sgpr_count 2
  .amdhsa_user_sgpr_kernarg_segment_ptr 1
  .amdhsa_system_sgpr_workgroup_id_x 1
  .amdhsa_float_denorm_mode_32 3
.end_amdhsa_kernel
```
